```python
import torch

def _softmax(x, axis=-1):
    return torch.softmax(x, dim=axis)
def _gelu(x):
    return torch.nn.functional.gelu(x, approximate="tanh")
def _silu(x):
    return torch.nn.functional.silu(x)
def _sigmoid(x):
    return torch.sigmoid(x)
def _layernorm(x, axis=-1, eps=1e-5):
    m = x.mean(dim=axis, keepdim=True)
    v = x.var(dim=axis, keepdim=True, unbiased=False)
    return (x - m) / torch.sqrt(v + eps)
def _scatter_add(tgt, idx, src, axis=0):
    return tgt.clone().index_add_(axis, idx, src)
def _segment_sum(src, seg, n):
    out = torch.zeros((n,) + src.shape[1:], dtype=src.dtype)
    return out.index_add_(0, seg, src)
def _pad(x, pw):
    flat = tuple(v for pair in reversed(pw) for v in pair)
    return torch.nn.functional.pad(x, flat)

kernel_name = 'sequential_preLN__sliding_block_cached__mixer_channel_mlp__decode'

def setup_inputs():

    _w = (lambda a: (lambda t: t.to(torch.bfloat16) if t.is_floating_point() else t)(torch.as_tensor(a)))
    def _A_setup():
        B, Sq, D = 2, 1, 576
        Hq, Hkv, Sk, Dh = 32, 16, 32768, 128
        assert Hq % Hkv == 0, (Hq, Hkv)
        return {
            "x": _w((lambda *s: torch.randn(*s, dtype=torch.bfloat16) * 0.05)(B, Sq, D)),
            "k_cache": _w((lambda *s: torch.randn(*s, dtype=torch.bfloat16) * 3.2)(B, Hkv, Sk, Dh)),
            "v_cache": _w((lambda *s: torch.randn(*s, dtype=torch.bfloat16) * 0.4)(B, Hkv, Sk, Dh)),
            "wq": _w((lambda *s: torch.randn(*s, dtype=torch.bfloat16) * 3.2)(D, Hq * Dh) * (D ** -0.5)),
            "wo": _w((lambda *s: torch.randn(*s, dtype=torch.bfloat16) * 0.4)(Hq * Dh, D) * ((Hq * Dh) ** -0.5)),
        }
    _A_in = _A_setup()

    def _B_setup():
        B, S, D, F = 2, 1, 576, 4608
        return {
            "x": _w((lambda *s: torch.randn(*s, dtype=torch.bfloat16) * 0.05)(B, S, D)),
            "w1": _w((lambda *s: torch.randn(*s, dtype=torch.bfloat16) * 3.2)(D, F) * (D ** -0.5)),
            "b1": _w((lambda *s: torch.randn(*s, dtype=torch.bfloat16) * 3.2)(F)),
            "w2": _w((lambda *s: torch.randn(*s, dtype=torch.bfloat16) * 0.8)(F, D) * (F ** -0.5)),
            "b2": _w((lambda *s: torch.randn(*s, dtype=torch.bfloat16) * 1.6)(D)),
        }
    _B_in = _B_setup()

    return {
        "A_x": _A_in["x"],
        "A_k_cache": _A_in["k_cache"],
        "A_v_cache": _A_in["v_cache"],
        "A_wq": _A_in["wq"],
        "A_wo": _A_in["wo"],
        "B_x": _B_in["x"],
        "B_w1": _B_in["w1"],
        "B_b1": _B_in["b1"],
        "B_w2": _B_in["w2"],
        "B_b2": _B_in["b2"],
    }

def reference(A_x, A_k_cache, A_v_cache, A_wq, A_wo, B_x, B_w1, B_b1, B_w2, B_b2):
    def _A_ref(x, k_cache, v_cache, wq, wo):
        B, Sq, D = x.shape
        Hq, Dh = 32, 128
        Hkv, Sk = k_cache.shape[1], k_cache.shape[2]
        W = min(4096, max(256, Sk // 4))
        rep = Hq // Hkv
        q = (lambda x, *d: x.permute(*d))((x @ wq).reshape(B, Sq, Hq, Dh), 0, 2, 1, 3)
        k = (lambda x, n, axis: torch.repeat_interleave(x, n, dim=axis))(k_cache[:, :, Sk - W:, :], rep, axis=1)
        v = (lambda x, n, axis: torch.repeat_interleave(x, n, dim=axis))(v_cache[:, :, Sk - W:, :], rep, axis=1)
        scores = torch.einsum("bhqd,bhkd->bhqk", q, k) * (Dh ** -0.5)
        p = _softmax(scores, axis=-1)
        o = torch.einsum("bhqk,bhkd->bhqd", p, v)
        return (lambda x, *d: x.permute(*d))(o, 0, 2, 1, 3).reshape(B, Sq, Hq * Dh) @ wo

    def _B_ref(x, w1, b1, w2, b2):
        y = _layernorm(x, axis=-1)
        h = _gelu(torch.einsum("bsd,df->bsf", y, w1) + b1)
        return torch.einsum("bsf,fd->bsd", h, w2) + b2

    x = A_x
    h = x + _A_ref(_layernorm(x, axis=-1), A_k_cache, A_v_cache, A_wq, A_wo)
    h2 = h + _B_ref(_layernorm(h, axis=-1), B_w1, B_b1, B_w2, B_b2)
    return h2
```

```asm
; @launch grid=(256,1,1) block=(576,1,1) lds=118784
.amdgcn_target "amdgcn-amd-amdhsa--gfx950"
.text
.globl sequential_preLN__sliding_block_cached__mixer_channel_mlp__decode_kernel
.type L_front,@object
L_front:
.fill 768, 4, 0
.p2align 8
.type sequential_preLN__sliding_block_cached__mixer_channel_mlp__decode_kernel,@function
sequential_preLN__sliding_block_cached__mixer_channel_mlp__decode_kernel:
    s_load_dwordx16 s[4:19], s[0:1], 0
    s_load_dwordx2 s[28:29], s[0:1], 96
    v_readfirstlane_b32 s33, v0
    s_cmpk_ge_u32 s2, 0x100
    s_cbranch_scc1 L_exit
    s_getpc_b64 s[48:49]
L_pc:
    s_lshr_b32 s32, s2, 3
    s_cmp_eq_u32 s33, 0
    s_cbranch_scc1 L_svc0
    s_and_b32 s3, s32, 1
    s_mulk_i32 s3, 7040
    s_addk_i32 s3, -8192
    v_min_u32 v1, 118, v0
    v_lshl_add_u32 v1, v1, 7, s3
    global_load_dword v7, v1, s[48:49]
    v_and_b32 v0, 63, v0
    v_lshrrev_b32 v4, 3, v0
    v_and_b32 v3, 6, v4
    v_xor_b32 v3, v3, v0
    v_and_b32 v3, 7, v3
    v_lshlrev_b32 v3, 4, v3
    v_lshl_add_u32 v3, v4, 13, v3
    s_lshl4_add_u32 m0, s33, 23552
    s_and_b32 s31, s2, 7
    s_lshr_b32 s37, s32, 4
    s_lshl1_add_u32 s37, s31, s37
    s_bfe_u32 s44, s32, 0x20002
    s_mulk_i32 s44, 1152
    s_add_u32 s44, s44, s33
    s_addk_i32 s44, -64
    s_and_b32 s45, s32, 3
    s_lshl2_add_u32 s45, s37, s45
    s_lshl3_add_u32 s44, s44, s45
    s_lshl_b32 s44, s44, 7
    v_add_u32 v3, s44, v3
    s_mov_b32 s44, 0x80000
    v_add_u32 v4, s44, v3
    v_add_u32 v5, s44, v4
    s_waitcnt lgkmcnt(0)
    global_load_lds_dwordx4 v3, s[10:11] nt
    s_addk_i32 m0, 0x2000
    s_cmpk_lt_u32 s33, 192
    global_load_lds_dwordx4 v4, s[10:11] nt
    s_cbranch_scc0 L_stream
    s_addk_i32 m0, 0x2000
    s_nop 0
    global_load_lds_dwordx4 v5, s[10:11] nt
    s_branch L_stream
L_end256:
.p2align 8
L_svc0:
    s_setprio 3
    v_mul_u32_u24 v2, 36, v0
    s_waitcnt lgkmcnt(0)
    global_load_dwordx4 v[10:13], v2, s[4:5]
    global_load_dwordx4 v[14:17], v2, s[4:5] offset:16
    global_load_dword v18, v2, s[4:5] offset:32
    v_lshlrev_b32 v40, 2, v0
    v_mov_b32 v56, -1
    v_mov_b32 v57, -1
    v_mov_b32 v3, 0
    v_mov_b32 v4, 0x3f803f80
    ds_write2st64_b32 v40, v56, v57 offset0:9 offset1:10
    ds_write2st64_b32 v40, v3, v4 offset0:11 offset1:12
    s_and_b32 s44, s32, 3
    s_lshr_b32 s3, s32, 2
    s_lshl3_add_u32 s44, s44, s3
    s_and_b32 s3, s2, 7
    s_lshl3_add_u32 s44, s44, s3
    s_lshl_b32 s44, s44, 7
    s_add_u32 s44, s44, 32768
    s_memtime s[46:47]
    s_waitcnt lgkmcnt(0)
    s_load_dword s3, s[28:29], s44
    s_barrier
    s_waitcnt lgkmcnt(0)
    s_memtime s[44:45]
    s_load_dwordx8 s[20:27], s[0:1], 64
    s_branch L_service
L_stream:
    s_lshl_b32 s44, s31, 5
    s_add_u32 s44, s44, s32
    s_lshl_b32 s44, s44, 9
    s_add_u32 s44, s44, s33
    s_addk_i32 s44, -64
    s_mulk_i32 s44, 36
    v_min_u32 v23, 17, v0
    v_lshl_add_u32 v23, v23, 7, s44
    global_load_dword v23, v23, s[12:13]
    s_mov_b32 s44, 0x3c2b1a0d
    s_mov_b32 s45, 0x806f5e4d
    s_cmp_ge_u32 s32, 24
    s_cselect_b32 s44, 0x3c2a1c0e, s44
    s_cselect_b32 s45, 0x806f5e4d, s45
    s_lshl_b32 s46, s32, 3
    s_lshr_b64 s[44:45], s[44:45], s46
    s_mul_i32 s45, s31, 5
    s_add_u32 s44, s44, s45
    s_lshr_b32 s45, s32, 3
    s_mul_i32 s45, s45, 9
    s_add_u32 s44, s44, s45
    s_add_u32 s44, s44, 115
    s_and_b32 s44, s44, 127
    s_lshl_b32 s44, s44, 13
    s_lshl4_add_u32 s46, s33, -1024
    s_add_u32 s46, s46, s44
    v_bfe_u32 v5, v0, 2, 2
    v_lshrrev_b32 v4, 4, v0
    v_and_b32 v1, 3, v0
    v_lshl_add_u32 v1, v1, 4, s46
    v_lshl_add_u32 v1, v4, 6, v1
    v_lshl_add_u32 v1, v5, 8, v1
    s_and_b32 s3, s32, 8
    s_lshl1_add_u32 s3, s3, s37
    s_lshl3_add_u32 s3, s3, 7
    s_lshl_b32 s3, s3, 20
    s_add_u32 s6, s6, s3
    s_addc_u32 s7, s7, 0
    s_mov_b32 s57, 0xfffff
    s_barrier
    global_load_dwordx4 v[44:47], v1, s[6:7] nt
    v_add_u32 v1, 0x2000, v1
    v_and_b32 v1, s57, v1
    global_load_dwordx4 v[48:51], v1, s[6:7] nt
    v_add_u32 v1, 0x2000, v1
    v_and_b32 v1, s57, v1
    global_load_dwordx4 v[52:55], v1, s[6:7] nt
    v_add_u32 v1, 0x2000, v1
    v_and_b32 v1, s57, v1
    s_lshl2_add_u32 s47, s32, L_table-L_pc
    s_load_dword s30, s[48:49], s47
    s_load_dwordx8 s[20:27], s[0:1], 64
    s_lshr_b32 s33, s33, 6
    s_sub_u32 s39, s33, 1
    s_sub_u32 s46, s46, 40960
    s_and_b32 s46, s46, s57
    v_lshl_add_u32 v2, v0, 4, s46
    s_add_u32 s8, s8, s3
    s_addc_u32 s9, s9, 0
    v_mov_b32 v24, 0
    v_mov_b32 v96, 0
    v_mov_b32 v25, 0
    v_mov_b32 v97, 0
    v_mov_b32 v26, 0
    v_mov_b32 v98, 0
    v_mov_b32 v27, 0
    v_mov_b32 v99, 0
    v_mov_b32 v28, 0
    v_mov_b32 v100, 0
    v_mov_b32 v29, 0
    v_mov_b32 v101, 0
    v_mov_b32 v30, 0
    v_mov_b32 v102, 0
    v_mov_b32 v31, 0
    v_mov_b32 v103, 0
    v_mov_b32 v32, 0
    v_mov_b32 v104, 0
    v_mov_b32 v33, 0
    v_mov_b32 v105, 0
    v_mov_b32 v34, 0
    v_mov_b32 v106, 0
    v_mov_b32 v35, 0
    v_mov_b32 v107, 0
    v_mov_b32 v36, 0
    v_mov_b32 v108, 0
    v_mov_b32 v37, 0
    v_mov_b32 v109, 0
    v_mov_b32 v38, 0
    v_mov_b32 v110, 0
    v_mov_b32 v39, 0
    v_mov_b32 v111, 0
    v_mov_b32 v40, 0
    v_mov_b32 v112, 0
    v_mov_b32 v41, 0
    v_mov_b32 v113, 0
    v_mov_b32 v42, 0
    v_mov_b32 v114, 0
    v_mov_b32 v43, 0
    v_mov_b32 v115, 0
    v_and_b32 v3, 1, v0
    v_lshlrev_b32 v3, 4, v3
    s_mov_b32 s47, 0xffff
    v_lshlrev_b32 v3, v3, s47
    v_bfe_u32 v4, v0, 1, 2
    v_cmp_eq_u32 vcc, 0, v4
    s_nop 1
    v_cndmask_b32 v12, 0, v3, vcc
    v_cmp_eq_u32 vcc, 1, v4
    s_nop 1
    v_cndmask_b32 v13, 0, v3, vcc
    v_cmp_eq_u32 vcc, 2, v4
    s_nop 1
    v_cndmask_b32 v14, 0, v3, vcc
    v_cmp_eq_u32 vcc, 3, v4
    s_nop 1
    v_cndmask_b32 v15, 0, v3, vcc
    v_bfe_u32 v3, v0, 3, 1
    v_lshrrev_b32 v4, 4, v0
    v_and_b32 v20, 3, v0
    v_lshlrev_b32 v20, 4, v20
    v_lshl_add_u32 v20, v4, 6, v20
    v_lshl_add_u32 v20, v3, 8, v20
    s_lshl_b32 s3, s39, 2
    v_mov_b32 v3, s3
    v_mov_b32 v4, 1
    s_waitcnt lgkmcnt(0)
    s_bfe_u32 s34, s30, 0x50008
    s_bfe_u32 s35, s30, 0x20010
    s_bfe_u32 s36, s30, 0x50018
    s_waitcnt vmcnt(3)
    global_load_dwordx4 v[56:59], v1, s[6:7] nt
    v_add_u32 v1, 0x2000, v1
    v_and_b32 v1, s57, v1
    ds_write_b32 v3, v4 offset:2944
    s_waitcnt vmcnt(5)
    global_load_dwordx4 v[60:63], v1, s[6:7] nt
    v_add_u32 v1, 0x2000, v1
    v_and_b32 v1, s57, v1
    s_waitcnt vmcnt(5)
    global_load_dwordx4 v[64:67], v1, s[6:7] nt
    v_add_u32 v1, 0x2000, v1
    v_and_b32 v1, s57, v1
    s_waitcnt vmcnt(5)
    global_load_dwordx4 v[68:71], v1, s[6:7] nt
    v_add_u32 v1, 0x2000, v1
    v_and_b32 v1, s57, v1
    s_waitcnt vmcnt(5)
    global_load_dwordx4 v[72:75], v1, s[6:7] nt
    v_add_u32 v1, 0x2000, v1
    v_and_b32 v1, s57, v1
    s_waitcnt vmcnt(5)
    global_load_dwordx4 v[76:79], v1, s[6:7] nt
    v_add_u32 v1, 0x2000, v1
    v_and_b32 v1, s57, v1
    s_waitcnt vmcnt(5)
    global_load_dwordx4 v[80:83], v1, s[6:7] nt
    v_add_u32 v1, 0x2000, v1
    v_and_b32 v1, s57, v1
    s_waitcnt vmcnt(5)
    global_load_dwordx4 v[84:87], v1, s[6:7] nt
    v_add_u32 v1, 0x2000, v1
    v_and_b32 v1, s57, v1
    s_waitcnt vmcnt(5)
    global_load_dwordx4 v[88:91], v1, s[6:7] nt
    v_add_u32 v1, 0x2000, v1
    v_and_b32 v1, s57, v1
    s_waitcnt vmcnt(5)
    global_load_dwordx4 v[92:95], v1, s[6:7] nt
    v_subrev_u32 v1, 139264, v1
    v_and_b32 v1, s57, v1
    s_cmp_ge_u32 s34, 18
    s_cbranch_scc0 L_skipK0
    s_waitcnt vmcnt(5)
    global_load_dwordx4 v[24:27], v1, s[6:7] nt
L_skipK0:
    v_add_u32 v1, 0x2000, v1
    v_and_b32 v1, s57, v1
    s_cmp_ge_u32 s34, 17
    s_cbranch_scc0 L_skipK1
    s_waitcnt vmcnt(5)
    global_load_dwordx4 v[28:31], v1, s[6:7] nt
L_skipK1:
    v_add_u32 v1, 0x2000, v1
    v_and_b32 v1, s57, v1
    s_cmp_ge_u32 s34, 16
    s_cbranch_scc0 L_skipK2
    s_waitcnt vmcnt(5)
    global_load_dwordx4 v[32:35], v1, s[6:7] nt
L_skipK2:
    v_add_u32 v1, 0x2000, v1
    v_and_b32 v1, s57, v1
    s_cmp_ge_u32 s34, 15
    s_cbranch_scc0 L_skipK3
    s_waitcnt vmcnt(5)
    global_load_dwordx4 v[36:39], v1, s[6:7] nt
L_skipK3:
    v_add_u32 v1, 0x2000, v1
    v_and_b32 v1, s57, v1
    s_cmp_ge_u32 s34, 14
    s_cbranch_scc0 L_skipK4
    s_waitcnt vmcnt(5)
    global_load_dwordx4 v[40:43], v1, s[6:7] nt
L_skipK4:
    s_cmp_eq_u32 s35, 1
    s_cbranch_scc0 L_nowo
    s_mov_b32 s40, s12
    s_mov_b32 s41, s13
    s_mov_b32 s42, 4718592
    s_mov_b32 s43, 0x20000
    v_lshrrev_b32 v4, 3, v0
    v_and_b32 v3, 6, v4
    v_xor_b32 v3, v3, v0
    v_and_b32 v3, 7, v3
    v_lshlrev_b32 v3, 4, v3
    v_and_b32 v4, 3, v4
    v_lshrrev_b32 v5, 5, v0
    v_lshl_add_u32 v4, v5, 4, v4
    v_mul_u32_u24 v4, 1152, v4
    v_add_u32 v3, v3, v4
    s_lshl_b32 s44, s31, 9
    s_lshr_b32 s45, s39, 1
    s_lshl_b32 s45, s45, 7
    s_add_u32 s44, s44, s45
    s_and_b32 s45, s39, 1
    s_lshl2_add_u32 s44, s45, s44
    s_mul_i32 s44, s44, 1152
    s_lshl_b32 s45, s36, 7
    s_add_u32 s44, s44, s45
    s_lshl_b32 s47, s39, 13
    s_add_u32 s47, s47, 45056
    s_add_u32 s45, s44, 0
    s_add_u32 m0, s47, 0
    s_waitcnt vmcnt(5)
    buffer_load_dwordx4 v3, s[40:43], s45 offen nt lds
    s_add_u32 s45, s44, 36864
    s_add_u32 m0, s47, 1024
    s_waitcnt vmcnt(5)
    buffer_load_dwordx4 v3, s[40:43], s45 offen nt lds
    s_add_u32 s45, s44, 9216
    s_add_u32 m0, s47, 2048
    s_waitcnt vmcnt(5)
    buffer_load_dwordx4 v3, s[40:43], s45 offen nt lds
    s_add_u32 s45, s44, 46080
    s_add_u32 m0, s47, 3072
    s_waitcnt vmcnt(5)
    buffer_load_dwordx4 v3, s[40:43], s45 offen nt lds
    s_add_u32 s45, s44, 73728
    s_add_u32 m0, s47, 4096
    s_waitcnt vmcnt(5)
    buffer_load_dwordx4 v3, s[40:43], s45 offen nt lds
    s_add_u32 s45, s44, 110592
    s_add_u32 m0, s47, 5120
    s_waitcnt vmcnt(5)
    buffer_load_dwordx4 v3, s[40:43], s45 offen nt lds
    s_add_u32 s45, s44, 82944
    s_add_u32 m0, s47, 6144
    s_waitcnt vmcnt(5)
    buffer_load_dwordx4 v3, s[40:43], s45 offen nt lds
    s_add_u32 s45, s44, 119808
    s_add_u32 m0, s47, 7168
    s_waitcnt vmcnt(5)
    buffer_load_dwordx4 v3, s[40:43], s45 offen nt lds
L_nowo:
    s_mov_b32 s40, s16
    s_mov_b32 s41, s17
    s_mov_b32 s42, 5308416
    s_mov_b32 s43, 0x20000
    s_mov_b32 s52, s20
    s_mov_b32 s53, s21
    s_mov_b32 s54, 5308416
    s_mov_b32 s55, 0x20000
    s_lshl_b32 s50, s33, 12
    s_add_u32 s50, s50, 45056
    v_lshrrev_b32 v6, 3, v0
    v_and_b32 v4, 2, v6
    v_bfe_u32 v3, v0, 2, 1
    v_lshl_add_u32 v6, v3, 4, v6
    v_mul_u32_u24 v6, 9216, v6
    v_xor_b32 v3, v4, v0
    v_and_b32 v3, 3, v3
    v_lshl_add_u32 v6, v3, 4, v6
    v_lshrrev_b32 v3, 3, v0
    v_and_b32 v7, 6, v3
    v_xor_b32 v7, v7, v0
    v_and_b32 v7, 7, v7
    v_lshlrev_b32 v7, 4, v7
    v_mul_u32_u24 v3, 1152, v3
    v_add_u32 v7, v7, v3
    v_bfe_u32 v3, v0, 2, 1
    v_and_b32 v21, 3, v0
    v_lshl_add_u32 v21, v3, 4, v21
    v_lshrrev_b32 v3, 4, v0
    v_lshl_add_u32 v21, v3, 2, v21
    v_lshlrev_b32 v21, 1, v21
    s_lshl_b32 s3, s39, 2
    v_mov_b32 v1, s3
    s_cmp_ge_u32 s34, 18
    s_cbranch_scc0 L_skipV0
    s_waitcnt vmcnt(3)
    global_load_dwordx4 v[96:99], v2, s[8:9] nt
L_skipV0:
    v_add_u32 v2, 0x2000, v2
    v_and_b32 v2, s57, v2
    s_cmp_ge_u32 s34, 17
    s_cbranch_scc0 L_skipV1
    s_waitcnt vmcnt(3)
    global_load_dwordx4 v[100:103], v2, s[8:9] nt
L_skipV1:
    v_add_u32 v2, 0x2000, v2
    v_and_b32 v2, s57, v2
    s_cmp_ge_u32 s34, 16
    s_cbranch_scc0 L_skipV2
    s_waitcnt vmcnt(3)
    global_load_dwordx4 v[104:107], v2, s[8:9] nt
L_skipV2:
    v_add_u32 v2, 0x2000, v2
    v_and_b32 v2, s57, v2
    s_cmp_ge_u32 s34, 15
    s_cbranch_scc0 L_skipV3
    s_waitcnt vmcnt(3)
    global_load_dwordx4 v[108:111], v2, s[8:9] nt
L_skipV3:
    v_add_u32 v2, 0x2000, v2
    v_and_b32 v2, s57, v2
    s_cmp_ge_u32 s34, 14
    s_cbranch_scc0 L_skipV4
    s_waitcnt vmcnt(3)
    global_load_dwordx4 v[112:115], v2, s[8:9] nt
L_skipV4:
    v_add_u32 v2, 0x2000, v2
    v_and_b32 v2, s57, v2
    s_waitcnt vmcnt(3)
    global_load_dwordx4 v[116:119], v2, s[8:9] nt
    v_add_u32 v2, 0x2000, v2
    v_and_b32 v2, s57, v2
    s_waitcnt vmcnt(3)
    global_load_dwordx4 v[120:123], v2, s[8:9] nt
    v_add_u32 v2, 0x2000, v2
    v_and_b32 v2, s57, v2
    s_waitcnt vmcnt(3)
    global_load_dwordx4 v[124:127], v2, s[8:9] nt
    v_add_u32 v2, 0x2000, v2
    v_and_b32 v2, s57, v2
    s_waitcnt vmcnt(3)
    global_load_dwordx4 v[128:131], v2, s[8:9] nt
    v_add_u32 v2, 0x2000, v2
    v_and_b32 v2, s57, v2
    s_waitcnt vmcnt(3)
    global_load_dwordx4 v[132:135], v2, s[8:9] nt
    v_add_u32 v2, 0x2000, v2
    v_and_b32 v2, s57, v2
    s_waitcnt vmcnt(3)
    global_load_dwordx4 v[136:139], v2, s[8:9] nt
    v_add_u32 v2, 0x2000, v2
    v_and_b32 v2, s57, v2
    s_cmp_ge_u32 s34, 18
    s_cselect_b32 s94, 0, 0xff800000
    s_cmp_ge_u32 s34, 17
    s_cselect_b32 s95, 0, 0xff800000
    s_cmp_ge_u32 s34, 16
    s_cselect_b32 s96, 0, 0xff800000
    s_cmp_ge_u32 s34, 15
    s_cselect_b32 s97, 0, 0xff800000
    s_cmp_ge_u32 s34, 14
    s_cselect_b32 s98, 0, 0xff800000
    s_mov_b32 s61, 1035273459
    s_mov_b32 s62, 1069066811
    s_mov_b32 s46, 2097152
    s_waitcnt vmcnt(3)
    global_load_dwordx4 v[140:143], v2, s[8:9] nt
    v_add_u32 v2, 0x2000, v2
    v_and_b32 v2, s57, v2
L_qw:
    ds_read_b128 v[8:11], v20 offset:2304
    s_waitcnt lgkmcnt(0)
    v_max3_u32 v3, v8, v9, v10
    v_max_u32 v3, v3, v11
    v_cmp_eq_u32 vcc, -1, v3
    s_cbranch_vccz L_qok
    s_sleep 1
    s_sub_u32 s46, s46, 1
    s_cbranch_scc0 L_qw
L_qok:
    v_mfma_f32_16x16x32_bf16 v[24:27], v[24:27], v[8:11], 0
    v_mfma_f32_16x16x32_bf16 v[28:31], v[28:31], v[8:11], 0
    v_mfma_f32_16x16x32_bf16 v[32:35], v[32:35], v[8:11], 0
    v_mfma_f32_16x16x32_bf16 v[36:39], v[36:39], v[8:11], 0
    s_nop 4
    v_add_f32 v27, s94, v27
    v_mov_b32_dpp v24, v24 quad_perm:[0,0,0,0] row_mask:0xf bank_mask:0x5
    v_add_f32_dpp v24, v25, v24 quad_perm:[1,1,1,1] row_mask:0xf bank_mask:0x5
    v_add_f32_dpp v24, v26, v24 quad_perm:[2,2,2,2] row_mask:0xf bank_mask:0x5
    v_add_f32_dpp v24, v27, v24 quad_perm:[3,3,3,3] row_mask:0xf bank_mask:0x5
    v_mfma_f32_16x16x32_bf16 v[40:43], v[40:43], v[8:11], 0
    v_add_f32 v31, s95, v31
    v_mov_b32_dpp v24, v28 quad_perm:[0,0,0,0] row_mask:0xf bank_mask:0xa
    v_add_f32_dpp v24, v29, v24 quad_perm:[1,1,1,1] row_mask:0xf bank_mask:0xa
    v_add_f32_dpp v24, v30, v24 quad_perm:[2,2,2,2] row_mask:0xf bank_mask:0xa
    v_add_f32_dpp v24, v31, v24 quad_perm:[3,3,3,3] row_mask:0xf bank_mask:0xa
    v_mfma_f32_16x16x32_bf16 v[44:47], v[44:47], v[8:11], 0
    v_add_f32 v35, s96, v35
    v_mov_b32_dpp v32, v32 quad_perm:[0,0,0,0] row_mask:0xf bank_mask:0x5
    v_add_f32_dpp v32, v33, v32 quad_perm:[1,1,1,1] row_mask:0xf bank_mask:0x5
    v_add_f32_dpp v32, v34, v32 quad_perm:[2,2,2,2] row_mask:0xf bank_mask:0x5
    v_add_f32_dpp v32, v35, v32 quad_perm:[3,3,3,3] row_mask:0xf bank_mask:0x5
    v_mfma_f32_16x16x32_bf16 v[48:51], v[48:51], v[8:11], 0
    v_add_f32 v39, s97, v39
    v_mov_b32_dpp v32, v36 quad_perm:[0,0,0,0] row_mask:0xf bank_mask:0xa
    v_add_f32_dpp v32, v37, v32 quad_perm:[1,1,1,1] row_mask:0xf bank_mask:0xa
    v_add_f32_dpp v32, v38, v32 quad_perm:[2,2,2,2] row_mask:0xf bank_mask:0xa
    v_add_f32_dpp v32, v39, v32 quad_perm:[3,3,3,3] row_mask:0xf bank_mask:0xa
    v_mfma_f32_16x16x32_bf16 v[52:55], v[52:55], v[8:11], 0
    v_add_f32 v43, s98, v43
    v_mov_b32_dpp v40, v40 quad_perm:[0,0,0,0] row_mask:0xf bank_mask:0x5
    v_add_f32_dpp v40, v41, v40 quad_perm:[1,1,1,1] row_mask:0xf bank_mask:0x5
    v_add_f32_dpp v40, v42, v40 quad_perm:[2,2,2,2] row_mask:0xf bank_mask:0x5
    v_add_f32_dpp v40, v43, v40 quad_perm:[3,3,3,3] row_mask:0xf bank_mask:0x5
    v_mfma_f32_16x16x32_bf16 v[56:59], v[56:59], v[8:11], 0
    v_mov_b32_dpp v40, v44 quad_perm:[0,0,0,0] row_mask:0xf bank_mask:0xa
    v_add_f32_dpp v40, v45, v40 quad_perm:[1,1,1,1] row_mask:0xf bank_mask:0xa
    v_add_f32_dpp v40, v46, v40 quad_perm:[2,2,2,2] row_mask:0xf bank_mask:0xa
    v_add_f32_dpp v40, v47, v40 quad_perm:[3,3,3,3] row_mask:0xf bank_mask:0xa
    v_mfma_f32_16x16x32_bf16 v[60:63], v[60:63], v[8:11], 0
    v_mov_b32_dpp v48, v48 quad_perm:[0,0,0,0] row_mask:0xf bank_mask:0x5
    v_add_f32_dpp v48, v49, v48 quad_perm:[1,1,1,1] row_mask:0xf bank_mask:0x5
    v_add_f32_dpp v48, v50, v48 quad_perm:[2,2,2,2] row_mask:0xf bank_mask:0x5
    v_add_f32_dpp v48, v51, v48 quad_perm:[3,3,3,3] row_mask:0xf bank_mask:0x5
    v_mfma_f32_16x16x32_bf16 v[64:67], v[64:67], v[8:11], 0
    v_mov_b32_dpp v48, v52 quad_perm:[0,0,0,0] row_mask:0xf bank_mask:0xa
    v_add_f32_dpp v48, v53, v48 quad_perm:[1,1,1,1] row_mask:0xf bank_mask:0xa
    v_add_f32_dpp v48, v54, v48 quad_perm:[2,2,2,2] row_mask:0xf bank_mask:0xa
    v_add_f32_dpp v48, v55, v48 quad_perm:[3,3,3,3] row_mask:0xf bank_mask:0xa
    v_mfma_f32_16x16x32_bf16 v[68:71], v[68:71], v[8:11], 0
    v_mov_b32_dpp v56, v56 quad_perm:[0,0,0,0] row_mask:0xf bank_mask:0x5
    v_add_f32_dpp v56, v57, v56 quad_perm:[1,1,1,1] row_mask:0xf bank_mask:0x5
    v_add_f32_dpp v56, v58, v56 quad_perm:[2,2,2,2] row_mask:0xf bank_mask:0x5
    v_add_f32_dpp v56, v59, v56 quad_perm:[3,3,3,3] row_mask:0xf bank_mask:0x5
    v_mfma_f32_16x16x32_bf16 v[72:75], v[72:75], v[8:11], 0
    v_mov_b32_dpp v56, v60 quad_perm:[0,0,0,0] row_mask:0xf bank_mask:0xa
    v_add_f32_dpp v56, v61, v56 quad_perm:[1,1,1,1] row_mask:0xf bank_mask:0xa
    v_add_f32_dpp v56, v62, v56 quad_perm:[2,2,2,2] row_mask:0xf bank_mask:0xa
    v_add_f32_dpp v56, v63, v56 quad_perm:[3,3,3,3] row_mask:0xf bank_mask:0xa
    v_mfma_f32_16x16x32_bf16 v[76:79], v[76:79], v[8:11], 0
    v_mov_b32_dpp v64, v64 quad_perm:[0,0,0,0] row_mask:0xf bank_mask:0x5
    v_add_f32_dpp v64, v65, v64 quad_perm:[1,1,1,1] row_mask:0xf bank_mask:0x5
    v_add_f32_dpp v64, v66, v64 quad_perm:[2,2,2,2] row_mask:0xf bank_mask:0x5
    v_add_f32_dpp v64, v67, v64 quad_perm:[3,3,3,3] row_mask:0xf bank_mask:0x5
    v_mfma_f32_16x16x32_bf16 v[80:83], v[80:83], v[8:11], 0
    v_mov_b32_dpp v64, v68 quad_perm:[0,0,0,0] row_mask:0xf bank_mask:0xa
    v_add_f32_dpp v64, v69, v64 quad_perm:[1,1,1,1] row_mask:0xf bank_mask:0xa
    v_add_f32_dpp v64, v70, v64 quad_perm:[2,2,2,2] row_mask:0xf bank_mask:0xa
    v_add_f32_dpp v64, v71, v64 quad_perm:[3,3,3,3] row_mask:0xf bank_mask:0xa
    v_mfma_f32_16x16x32_bf16 v[84:87], v[84:87], v[8:11], 0
    v_mov_b32_dpp v72, v72 quad_perm:[0,0,0,0] row_mask:0xf bank_mask:0x5
    v_add_f32_dpp v72, v73, v72 quad_perm:[1,1,1,1] row_mask:0xf bank_mask:0x5
    v_add_f32_dpp v72, v74, v72 quad_perm:[2,2,2,2] row_mask:0xf bank_mask:0x5
    v_add_f32_dpp v72, v75, v72 quad_perm:[3,3,3,3] row_mask:0xf bank_mask:0x5
    v_mfma_f32_16x16x32_bf16 v[88:91], v[88:91], v[8:11], 0
    v_mov_b32_dpp v72, v76 quad_perm:[0,0,0,0] row_mask:0xf bank_mask:0xa
    v_add_f32_dpp v72, v77, v72 quad_perm:[1,1,1,1] row_mask:0xf bank_mask:0xa
    v_add_f32_dpp v72, v78, v72 quad_perm:[2,2,2,2] row_mask:0xf bank_mask:0xa
    v_add_f32_dpp v72, v79, v72 quad_perm:[3,3,3,3] row_mask:0xf bank_mask:0xa
    v_mfma_f32_16x16x32_bf16 v[92:95], v[92:95], v[8:11], 0
    v_mov_b32_dpp v80, v80 quad_perm:[0,0,0,0] row_mask:0xf bank_mask:0x5
    v_add_f32_dpp v80, v81, v80 quad_perm:[1,1,1,1] row_mask:0xf bank_mask:0x5
    v_add_f32_dpp v80, v82, v80 quad_perm:[2,2,2,2] row_mask:0xf bank_mask:0x5
    v_add_f32_dpp v80, v83, v80 quad_perm:[3,3,3,3] row_mask:0xf bank_mask:0x5
    v_mov_b32_dpp v80, v84 quad_perm:[0,0,0,0] row_mask:0xf bank_mask:0xa
    v_add_f32_dpp v80, v85, v80 quad_perm:[1,1,1,1] row_mask:0xf bank_mask:0xa
    v_add_f32_dpp v80, v86, v80 quad_perm:[2,2,2,2] row_mask:0xf bank_mask:0xa
    v_add_f32_dpp v80, v87, v80 quad_perm:[3,3,3,3] row_mask:0xf bank_mask:0xa
    v_mov_b32_dpp v88, v88 quad_perm:[0,0,0,0] row_mask:0xf bank_mask:0x5
    v_add_f32_dpp v88, v89, v88 quad_perm:[1,1,1,1] row_mask:0xf bank_mask:0x5
    v_add_f32_dpp v88, v90, v88 quad_perm:[2,2,2,2] row_mask:0xf bank_mask:0x5
    v_add_f32_dpp v88, v91, v88 quad_perm:[3,3,3,3] row_mask:0xf bank_mask:0x5
    v_mov_b32_dpp v88, v92 quad_perm:[0,0,0,0] row_mask:0xf bank_mask:0xa
    v_add_f32_dpp v88, v93, v88 quad_perm:[1,1,1,1] row_mask:0xf bank_mask:0xa
    v_add_f32_dpp v88, v94, v88 quad_perm:[2,2,2,2] row_mask:0xf bank_mask:0xa
    v_add_f32_dpp v88, v95, v88 quad_perm:[3,3,3,3] row_mask:0xf bank_mask:0xa
    s_waitcnt vmcnt(3)
    global_load_dwordx4 v[144:147], v2, s[8:9] nt
    v_add_u32 v2, 0x2000, v2
    v_and_b32 v2, s57, v2
    v_cvt_pk_bf16_f32 v3, v24, v32
    v_lshlrev_b32 v24, 16, v3
    v_and_b32 v32, 0xffff0000, v3
    v_mul_f32 v24, s61, v24
    v_mul_f32 v32, s61, v32
    v_cvt_pk_bf16_f32 v3, v24, v32
    v_lshlrev_b32 v24, 16, v3
    v_and_b32 v32, 0xffff0000, v3
    v_cvt_pk_bf16_f32 v3, v40, v48
    v_lshlrev_b32 v40, 16, v3
    v_and_b32 v48, 0xffff0000, v3
    v_mul_f32 v40, s61, v40
    v_mul_f32 v48, s61, v48
    v_cvt_pk_bf16_f32 v3, v40, v48
    v_lshlrev_b32 v40, 16, v3
    v_and_b32 v48, 0xffff0000, v3
    v_cvt_pk_bf16_f32 v3, v56, v64
    v_lshlrev_b32 v56, 16, v3
    v_and_b32 v64, 0xffff0000, v3
    v_mul_f32 v56, s61, v56
    v_mul_f32 v64, s61, v64
    v_cvt_pk_bf16_f32 v3, v56, v64
    v_lshlrev_b32 v56, 16, v3
    v_and_b32 v64, 0xffff0000, v3
    v_cvt_pk_bf16_f32 v3, v72, v80
    v_lshlrev_b32 v72, 16, v3
    v_and_b32 v80, 0xffff0000, v3
    v_mul_f32 v72, s61, v72
    v_mul_f32 v80, s61, v80
    v_cvt_pk_bf16_f32 v3, v72, v80
    v_lshlrev_b32 v72, 16, v3
    v_and_b32 v80, 0xffff0000, v3
    v_cvt_pk_bf16_f32 v88, v88, v88
    v_lshlrev_b32 v88, 16, v88
    v_mul_f32 v88, s61, v88
    v_cvt_pk_bf16_f32 v88, v88, v88
    v_lshlrev_b32 v88, 16, v88
    v_max3_f32 v4, v24, v32, v40
    v_max3_f32 v4, v48, v56, v4
    v_max3_f32 v4, v64, v72, v4
    v_max3_f32 v4, v80, v88, v4
    s_nop 1
    v_max_f32_dpp v4, v4, v4 row_half_mirror row_mask:0xf bank_mask:0xf
    v_mov_b32 v3, v4
    s_nop 1
    v_permlane16_swap_b32 v4, v3
    v_max_f32 v4, v4, v3
    v_mov_b32 v3, v4
    s_nop 1
    v_permlane32_swap_b32 v4, v3
    v_max_f32 v4, v4, v3
    v_mul_f32 v4, s62, v4
    v_mov_b32 v5, 0
    v_fma_f32 v24, v24, s62, -v4
    v_fma_f32 v32, v32, s62, -v4
    v_fma_f32 v40, v40, s62, -v4
    v_fma_f32 v48, v48, s62, -v4
    v_fma_f32 v56, v56, s62, -v4
    v_fma_f32 v64, v64, s62, -v4
    v_fma_f32 v72, v72, s62, -v4
    v_fma_f32 v80, v80, s62, -v4
    v_fma_f32 v88, v88, s62, -v4
    v_exp_f32 v24, v24
    v_exp_f32 v32, v32
    v_exp_f32 v40, v40
    v_exp_f32 v48, v48
    v_exp_f32 v56, v56
    v_exp_f32 v64, v64
    v_exp_f32 v72, v72
    v_exp_f32 v80, v80
    v_exp_f32 v88, v88
    v_add_f32 v5, v5, v24
    v_cvt_pk_bf16_f32 v24, v24, v24
    v_add_f32 v5, v5, v32
    v_cvt_pk_bf16_f32 v32, v32, v32
    v_add_f32 v5, v5, v40
    v_cvt_pk_bf16_f32 v40, v40, v40
    v_add_f32 v5, v5, v48
    v_cvt_pk_bf16_f32 v48, v48, v48
    v_add_f32 v5, v5, v56
    v_cvt_pk_bf16_f32 v56, v56, v56
    v_add_f32 v5, v5, v64
    v_cvt_pk_bf16_f32 v64, v64, v64
    v_add_f32 v5, v5, v72
    v_cvt_pk_bf16_f32 v72, v72, v72
    v_add_f32 v5, v5, v80
    v_cvt_pk_bf16_f32 v80, v80, v80
    v_add_f32 v5, v5, v88
    v_cvt_pk_bf16_f32 v88, v88, v88
    s_nop 0
    v_add_f32_dpp v5, v5, v5 row_half_mirror row_mask:0xf bank_mask:0xf
    v_mov_b32 v3, v5
    s_nop 1
    v_permlane16_swap_b32 v5, v3
    v_add_f32 v5, v5, v3
    v_mov_b32 v3, v5
    s_nop 1
    v_permlane32_swap_b32 v5, v3
    v_add_f32 v5, v5, v3
    v_bfe_u32 v3, v0, 3, 1
    s_lshl_b32 s3, s39, 3
    v_lshl_add_u32 v3, v3, 6, s3
    ds_write_b64 v3, v[4:5] offset:2816
    s_waitcnt vmcnt(3)
    global_load_dwordx4 v[148:151], v2, s[8:9] nt
    v_add_u32 v2, 0x2000, v2
    v_and_b32 v2, s57, v2
    v_and_b32 v31, v24, v15
    v_and_b32 v30, v24, v14
    v_and_b32_dpp v29, v24, v13 row_half_mirror row_mask:0xf bank_mask:0xf
    v_and_b32_dpp v28, v24, v12 row_half_mirror row_mask:0xf bank_mask:0xf
    v_and_b32_dpp v27, v24, v15 row_half_mirror row_mask:0xf bank_mask:0xf
    v_and_b32_dpp v26, v24, v14 row_half_mirror row_mask:0xf bank_mask:0xf
    v_and_b32 v25, v24, v13
    v_and_b32 v24, v24, v12
    v_and_b32 v39, v32, v15
    v_and_b32 v38, v32, v14
    v_and_b32_dpp v37, v32, v13 row_half_mirror row_mask:0xf bank_mask:0xf
    v_and_b32_dpp v36, v32, v12 row_half_mirror row_mask:0xf bank_mask:0xf
    v_and_b32_dpp v35, v32, v15 row_half_mirror row_mask:0xf bank_mask:0xf
    v_and_b32_dpp v34, v32, v14 row_half_mirror row_mask:0xf bank_mask:0xf
    v_and_b32 v33, v32, v13
    v_and_b32 v32, v32, v12
    v_and_b32 v47, v40, v15
    v_and_b32 v46, v40, v14
    v_and_b32_dpp v45, v40, v13 row_half_mirror row_mask:0xf bank_mask:0xf
    v_and_b32_dpp v44, v40, v12 row_half_mirror row_mask:0xf bank_mask:0xf
    v_and_b32_dpp v43, v40, v15 row_half_mirror row_mask:0xf bank_mask:0xf
    v_and_b32_dpp v42, v40, v14 row_half_mirror row_mask:0xf bank_mask:0xf
    v_and_b32 v41, v40, v13
    v_and_b32 v40, v40, v12
    v_and_b32 v55, v48, v15
    v_and_b32 v54, v48, v14
    v_and_b32_dpp v53, v48, v13 row_half_mirror row_mask:0xf bank_mask:0xf
    v_and_b32_dpp v52, v48, v12 row_half_mirror row_mask:0xf bank_mask:0xf
    v_and_b32_dpp v51, v48, v15 row_half_mirror row_mask:0xf bank_mask:0xf
    v_and_b32_dpp v50, v48, v14 row_half_mirror row_mask:0xf bank_mask:0xf
    v_and_b32 v49, v48, v13
    v_and_b32 v48, v48, v12
    v_and_b32 v63, v56, v15
    v_and_b32 v62, v56, v14
    v_and_b32_dpp v61, v56, v13 row_half_mirror row_mask:0xf bank_mask:0xf
    v_and_b32_dpp v60, v56, v12 row_half_mirror row_mask:0xf bank_mask:0xf
    v_and_b32_dpp v59, v56, v15 row_half_mirror row_mask:0xf bank_mask:0xf
    v_and_b32_dpp v58, v56, v14 row_half_mirror row_mask:0xf bank_mask:0xf
    v_and_b32 v57, v56, v13
    v_and_b32 v56, v56, v12
    v_and_b32 v71, v64, v15
    v_and_b32 v70, v64, v14
    v_and_b32_dpp v69, v64, v13 row_half_mirror row_mask:0xf bank_mask:0xf
    v_and_b32_dpp v68, v64, v12 row_half_mirror row_mask:0xf bank_mask:0xf
    v_and_b32_dpp v67, v64, v15 row_half_mirror row_mask:0xf bank_mask:0xf
    v_and_b32_dpp v66, v64, v14 row_half_mirror row_mask:0xf bank_mask:0xf
    v_and_b32 v65, v64, v13
    v_and_b32 v64, v64, v12
    v_and_b32 v79, v72, v15
    v_and_b32 v78, v72, v14
    v_and_b32_dpp v77, v72, v13 row_half_mirror row_mask:0xf bank_mask:0xf
    v_and_b32_dpp v76, v72, v12 row_half_mirror row_mask:0xf bank_mask:0xf
    v_and_b32_dpp v75, v72, v15 row_half_mirror row_mask:0xf bank_mask:0xf
    v_and_b32_dpp v74, v72, v14 row_half_mirror row_mask:0xf bank_mask:0xf
    v_and_b32 v73, v72, v13
    v_and_b32 v72, v72, v12
    v_and_b32 v87, v80, v15
    v_and_b32 v86, v80, v14
    v_and_b32_dpp v85, v80, v13 row_half_mirror row_mask:0xf bank_mask:0xf
    v_and_b32_dpp v84, v80, v12 row_half_mirror row_mask:0xf bank_mask:0xf
    v_and_b32_dpp v83, v80, v15 row_half_mirror row_mask:0xf bank_mask:0xf
    v_and_b32_dpp v82, v80, v14 row_half_mirror row_mask:0xf bank_mask:0xf
    v_and_b32 v81, v80, v13
    v_and_b32 v80, v80, v12
    v_and_b32 v95, v88, v15
    v_and_b32 v94, v88, v14
    v_and_b32_dpp v93, v88, v13 row_half_mirror row_mask:0xf bank_mask:0xf
    v_and_b32_dpp v92, v88, v12 row_half_mirror row_mask:0xf bank_mask:0xf
    v_and_b32_dpp v91, v88, v15 row_half_mirror row_mask:0xf bank_mask:0xf
    v_and_b32_dpp v90, v88, v14 row_half_mirror row_mask:0xf bank_mask:0xf
    v_and_b32 v89, v88, v13
    v_and_b32 v88, v88, v12
    s_lshl_b32 s3, s39, 10
    v_lshl_add_u32 v3, v0, 4, s3
    s_waitcnt vmcnt(3)
    global_load_dwordx4 v[152:155], v2, s[8:9] nt
    v_add_u32 v2, 0x2000, v2
    v_and_b32 v2, s57, v2
    v_mfma_f32_16x16x32_bf16 v[16:19], v[24:27], v[96:99], 0
    v_mfma_f32_16x16x32_bf16 v[16:19], v[28:31], v[100:103], v[16:19]
    v_mfma_f32_16x16x32_bf16 v[16:19], v[32:35], v[104:107], v[16:19]
    v_mfma_f32_16x16x32_bf16 v[16:19], v[36:39], v[108:111], v[16:19]
    v_mfma_f32_16x16x32_bf16 v[16:19], v[40:43], v[112:115], v[16:19]
    v_mfma_f32_16x16x32_bf16 v[16:19], v[44:47], v[116:119], v[16:19]
    v_mfma_f32_16x16x32_bf16 v[16:19], v[48:51], v[120:123], v[16:19]
    v_mfma_f32_16x16x32_bf16 v[16:19], v[52:55], v[124:127], v[16:19]
    v_mfma_f32_16x16x32_bf16 v[16:19], v[56:59], v[128:131], v[16:19]
    v_mfma_f32_16x16x32_bf16 v[16:19], v[60:63], v[132:135], v[16:19]
    v_mfma_f32_16x16x32_bf16 v[16:19], v[64:67], v[136:139], v[16:19]
    s_waitcnt vmcnt(3)
    global_load_dwordx4 v[156:159], v2, s[8:9] nt
    v_add_u32 v2, 0x2000, v2
    v_and_b32 v2, s57, v2
    v_mfma_f32_16x16x32_bf16 v[16:19], v[68:71], v[140:143], v[16:19]
    s_waitcnt vmcnt(3)
    global_load_dwordx4 v[160:163], v2, s[8:9] nt
    v_add_u32 v2, 0x2000, v2
    v_and_b32 v2, s57, v2
    v_mfma_f32_16x16x32_bf16 v[16:19], v[72:75], v[144:147], v[16:19]
    s_waitcnt vmcnt(3)
    global_load_dwordx4 v[164:167], v2, s[8:9] nt
    ds_write_b32 v1, v5 offset:2976
    v_mfma_f32_16x16x32_bf16 v[16:19], v[76:79], v[148:151], v[16:19]
    s_cmp_eq_u32 s35, 1
    s_cbranch_scc1 L_s1pre
    s_waitcnt vmcnt(3)
    v_mfma_f32_16x16x32_bf16 v[16:19], v[80:83], v[152:155], v[16:19]
    s_waitcnt vmcnt(2)
    v_mfma_f32_16x16x32_bf16 v[16:19], v[84:87], v[156:159], v[16:19]
    s_waitcnt vmcnt(1)
    v_mfma_f32_16x16x32_bf16 v[16:19], v[88:91], v[160:163], v[16:19]
    s_waitcnt vmcnt(0)
    v_mfma_f32_16x16x32_bf16 v[16:19], v[92:95], v[164:167], v[16:19]
    s_nop 7
    ds_write_b128 v3, v[16:19] offset:12288
    s_waitcnt lgkmcnt(0)
    s_barrier
    s_branch L_dyn
L_s1pre:
    s_lshr_b32 s44, s31, 1
    s_and_b32 s3, s31, 1
    s_lshl2_add_u32 s44, s44, s3
    s_lshl_b32 s44, s44, 12
    s_add_u32 s44, s44, 65536
    s_lshr_b32 s3, s39, 1
    s_lshl_b32 s3, s3, 6
    s_add_u32 s3, s3, s44
    s_add_u32 s3, s3, 2304
    v_and_b32 v1, 48, v0
    v_add_u32 v1, s3, v1
    s_lshl3_add_u32 s3, s31, s39
    s_lshl_b32 s3, s3, 11
    s_add_u32 s3, s3, 2097152
    v_lshl_add_u32 v2, v0, 4, s3
    v_lshrrev_b32 v8, 2, v0
    v_bfe_u32 v9, v0, 3, 2
    v_lshl_add_u32 v8, v8, 7, s47
    v_lshl_add_u32 v8, v9, 5, v8
    v_and_b32 v9, 3, v0
    v_lshl_add_u32 v4, v9, 3, v8
    v_xor_b32 v5, 64, v4
    v_xor_b32 v6, 32, v4
    v_xor_b32 v7, 96, v4
    ds_read_b64_tr_b16 v[96:97], v4 offset:0
    ds_read_b64_tr_b16 v[98:99], v4 offset:2048
    ds_read_b64_tr_b16 v[100:101], v5 offset:0
    ds_read_b64_tr_b16 v[102:103], v5 offset:2048
    ds_read_b64_tr_b16 v[104:105], v6 offset:0
    ds_read_b64_tr_b16 v[106:107], v6 offset:2048
    ds_read_b64_tr_b16 v[108:109], v7 offset:0
    ds_read_b64_tr_b16 v[110:111], v7 offset:2048
    ds_read_b64_tr_b16 v[112:113], v4 offset:4096
    ds_read_b64_tr_b16 v[114:115], v4 offset:6144
    ds_read_b64_tr_b16 v[116:117], v5 offset:4096
    ds_read_b64_tr_b16 v[118:119], v5 offset:6144
    ds_read_b64_tr_b16 v[120:121], v6 offset:4096
    ds_read_b64_tr_b16 v[122:123], v6 offset:6144
    ds_read_b64_tr_b16 v[124:125], v7 offset:4096
    ds_read_b64_tr_b16 v[126:127], v7 offset:6144
    s_lshl_b32 s3, s39, 9
    v_lshl_add_u32 v10, v0, 3, s3
    v_mov_b32 v11, 0
    s_mov_b32 s46, 262144
    s_waitcnt vmcnt(3)
    v_mfma_f32_16x16x32_bf16 v[16:19], v[80:83], v[152:155], v[16:19]
    s_waitcnt vmcnt(2)
    v_mfma_f32_16x16x32_bf16 v[16:19], v[84:87], v[156:159], v[16:19]
    s_waitcnt vmcnt(1)
    v_mfma_f32_16x16x32_bf16 v[16:19], v[88:91], v[160:163], v[16:19]
    s_waitcnt vmcnt(0)
    v_mfma_f32_16x16x32_bf16 v[16:19], v[92:95], v[164:167], v[16:19]
    s_nop 7
    ds_write_b128 v3, v[16:19] offset:12288
    s_waitcnt lgkmcnt(0)
    s_barrier
    ds_read_b32 v4, v11 offset:3608
    global_load_dwordx4 v[20:23], v1, s[28:29] sc1
    s_waitcnt lgkmcnt(0)
    v_add_u32 v2, v2, v4
    global_load_dwordx4 v[24:27], v2, s[28:29] sc1
    global_load_dwordx4 v[28:31], v2, s[28:29] offset:1024 sc1
    s_waitcnt vmcnt(2)
L_fw:
    v_max3_u32 v8, v20, v21, v22
    v_max_u32 v8, v8, v23
    v_cmp_eq_u32 vcc, -1, v8
    s_cbranch_vccnz L_fretry
L_fok:
    v_max3_f32 v8, v20, v21, v22
    v_max_f32 v8, v8, v23
    v_mov_b32 v9, v8
    s_nop 1
    v_permlane16_swap_b32 v8, v9
    v_max_f32 v8, v8, v9
    v_sub_f32 v20, v20, v8
    v_sub_f32 v21, v21, v8
    v_sub_f32 v22, v22, v8
    v_sub_f32 v23, v23, v8
    v_exp_f32 v20, v20
    v_exp_f32 v21, v21
    v_exp_f32 v22, v22
    v_exp_f32 v23, v23
    v_add_f32 v8, v20, v21
    v_add_f32 v9, v22, v23
    v_add_f32 v8, v8, v9
    v_mov_b32 v9, v8
    s_nop 1
    v_permlane16_swap_b32 v8, v9
    v_add_f32 v8, v8, v9
    v_rcp_f32 v8, v8
    s_nop 0
    v_mul_f32 v20, v8, v20
    v_mul_f32 v21, v8, v21
    v_mul_f32 v22, v8, v22
    v_mul_f32 v23, v8, v23
    s_mov_b32 s46, 262144
L_s1poll:
    s_waitcnt vmcnt(0)
    v_max3_u32 v8, v24, v25, v26
    v_max3_u32 v9, v27, v28, v29
    v_max3_u32 v8, v30, v31, v8
    v_max_u32 v8, v8, v9
    v_cmp_eq_u32 vcc, -1, v8
    s_cbranch_vccnz L_s1retry
L_s1go:
    v_mfma_f32_16x16x32_bf16 v[32:35], v[24:27], v[96:99], 0
    v_mfma_f32_16x16x32_bf16 v[32:35], v[28:31], v[112:115], v[32:35]
    v_mfma_f32_16x16x32_bf16 v[36:39], v[24:27], v[100:103], 0
    v_mfma_f32_16x16x32_bf16 v[36:39], v[28:31], v[116:119], v[36:39]
    v_mfma_f32_16x16x32_bf16 v[40:43], v[24:27], v[104:107], 0
    v_mfma_f32_16x16x32_bf16 v[40:43], v[28:31], v[120:123], v[40:43]
    v_mfma_f32_16x16x32_bf16 v[44:47], v[24:27], v[108:111], 0
    v_mfma_f32_16x16x32_bf16 v[44:47], v[28:31], v[124:127], v[44:47]
    s_nop 1
    v_pk_mul_f32 v[32:33], v[32:33], v[20:21]
    v_pk_fma_f32 v[32:33], v[34:35], v[22:23], v[32:33]
    v_add_f32 v32, v32, v33
    v_pk_mul_f32 v[36:37], v[36:37], v[20:21]
    v_pk_fma_f32 v[36:37], v[38:39], v[22:23], v[36:37]
    v_add_f32 v36, v36, v37
    v_pk_mul_f32 v[40:41], v[40:41], v[20:21]
    v_pk_fma_f32 v[40:41], v[42:43], v[22:23], v[40:41]
    v_add_f32 v40, v40, v41
    v_permlane16_swap_b32 v32, v36
    v_pk_mul_f32 v[44:45], v[44:45], v[20:21]
    v_pk_fma_f32 v[44:45], v[46:47], v[22:23], v[44:45]
    v_add_f32 v44, v44, v45
    v_add_f32 v32, v32, v36
    s_nop 0
    v_permlane16_swap_b32 v40, v44
    v_add_f32 v33, v40, v44
    ds_write_b64 v10, v[32:33] offset:20480
    s_waitcnt lgkmcnt(0)
    s_barrier
L_exit:
    s_endpgm
L_s1retry:
    s_sub_u32 s46, s46, 1
    s_cbranch_scc1 L_s1go
    s_mov_b64 exec, vcc
    global_load_dwordx4 v[24:27], v2, s[28:29] sc1
    global_load_dwordx4 v[28:31], v2, s[28:29] offset:1024 sc1
    s_mov_b64 exec, -1
    s_branch L_s1poll
L_fretry:
    s_sub_u32 s46, s46, 1
    s_cbranch_scc1 L_fok
    global_load_dwordx4 v[20:23], v1, s[28:29] sc1
    s_waitcnt vmcnt(0)
    s_branch L_fw
L_service:
    s_waitcnt lgkmcnt(0)
    s_sub_u32 s50, s44, s46
    s_min_u32 s50, s50, 0xfff
    s_lshl_b32 s50, s50, 4
    s_lshl2_add_u32 s47, s32, L_table-L_pc
    s_load_dword s30, s[48:49], s47
    s_load_dword s62, s[28:29], 0
    s_and_b32 s31, s2, 7
    s_lshr_b32 s37, s32, 4
    s_lshl1_add_u32 s37, s31, s37
    s_lshr_b32 s56, s31, 1
    s_and_b32 s3, s31, 1
    s_lshl2_add_u32 s56, s56, s3
    s_lshl_b32 s56, s56, 12
    s_add_u32 s56, s56, 65536
    s_lshl_b32 s44, s31, 5
    s_add_u32 s44, s44, s32
    s_lshl_b32 s3, s44, 9
    s_add_u32 s3, s3, 2097152
    v_lshl_add_u32 v19, v0, 3, s3
    global_store_dwordx2 v19, v[56:57], s[28:29]
    s_bfe_u32 s38, s32, 0x20002
    s_and_b32 s39, s32, 3
    s_getreg_b32 s51, hwreg(HW_REG_XCC_ID)
    s_and_b32 s51, s51, 15
    s_movk_i32 s57, 2304
    s_mov_b32 s3, 24576
    v_lshrrev_b32 v41, 2, v0
    v_bfe_u32 v42, v0, 3, 2
    v_lshl_add_u32 v41, v41, 7, s3
    v_lshl_add_u32 v41, v42, 5, v41
    v_and_b32 v42, 3, v0
    v_lshl_add_u32 v44, v42, 3, v41
    v_xor_b32 v45, 32, v44
    v_xor_b32 v46, 64, v44
    v_xor_b32 v47, 96, v44
    v_bfe_u32 v4, v0, 3, 1
    v_mul_u32_u24 v4, 1152, v4
    v_lshrrev_b32 v41, 4, v0
    v_lshl_add_u32 v4, v41, 3, v4
    s_mul_i32 s3, s38, 288
    v_add_u32 v4, s3, v4
    v_and_b32 v3, 16, v0
    v_cmp_ne_u32 s[58:59], 0, v3
    s_lshl2_add_u32 s3, s37, s38
    s_lshl3_add_u32 s3, s3, s39
    s_lshl_b32 s3, s3, 8
    s_add_u32 s3, s3, 2228224
    v_and_b32 v43, 31, v0
    v_lshl_add_u32 v43, v43, 3, s3
    v_lshrrev_b32 v3, 5, v0
    v_lshl_add_u32 v43, v3, 10, v43
    v_and_b32 v6, 28, v40
    s_cmp_eq_u32 s32, 2
    s_cbranch_scc0 L_c1
    v_mov_b32 v58, -1
    v_mov_b32 v59, -1
    v_lshl_add_u32 v3, v0, 4, s56
    global_store_dwordx4 v3, v[56:59], s[28:29] offset:0 sc1
    global_store_dwordx4 v3, v[56:59], s[28:29] offset:1024 sc1
    global_store_dwordx4 v3, v[56:59], s[28:29] offset:2048 sc1
    v_add_u32 v3, 8192, v3
    global_store_dwordx4 v3, v[56:59], s[28:29] offset:0 sc1
    global_store_dwordx4 v3, v[56:59], s[28:29] offset:1024 sc1
    global_store_dwordx4 v3, v[56:59], s[28:29] offset:2048 sc1
    s_waitcnt vmcnt(7)
    s_branch L_c1b
L_c1:
    s_waitcnt vmcnt(1)
L_c1b:
    v_lshlrev_b32 v20, 16, v10
    v_and_b32 v21, 0xffff0000, v10
    ds_write_b32 v2, v10 offset:20480
    v_lshlrev_b32 v22, 16, v11
    v_and_b32 v23, 0xffff0000, v11
    ds_write_b32 v2, v11 offset:20484
    v_lshlrev_b32 v24, 16, v12
    v_and_b32 v25, 0xffff0000, v12
    ds_write_b32 v2, v12 offset:20488
    v_lshlrev_b32 v26, 16, v13
    v_and_b32 v27, 0xffff0000, v13
    ds_write_b32 v2, v13 offset:20492
    v_lshlrev_b32 v28, 16, v14
    v_and_b32 v29, 0xffff0000, v14
    ds_write_b32 v2, v14 offset:20496
    v_lshlrev_b32 v30, 16, v15
    v_and_b32 v31, 0xffff0000, v15
    ds_write_b32 v2, v15 offset:20500
    v_lshlrev_b32 v32, 16, v16
    v_and_b32 v33, 0xffff0000, v16
    ds_write_b32 v2, v16 offset:20504
    v_lshlrev_b32 v34, 16, v17
    v_and_b32 v35, 0xffff0000, v17
    ds_write_b32 v2, v17 offset:20508
    v_lshlrev_b32 v36, 16, v18
    v_and_b32 v37, 0xffff0000, v18
    ds_write_b32 v2, v18 offset:20512
    v_pk_add_f32 v[38:39], v[20:21], v[22:23]
    v_pk_add_f32 v[38:39], v[38:39], v[24:25]
    v_pk_add_f32 v[38:39], v[38:39], v[26:27]
    v_pk_add_f32 v[38:39], v[38:39], v[28:29]
    v_pk_add_f32 v[38:39], v[38:39], v[30:31]
    v_pk_add_f32 v[38:39], v[38:39], v[32:33]
    v_pk_add_f32 v[38:39], v[38:39], v[34:35]
    v_pk_add_f32 v[38:39], v[38:39], v[36:37]
    v_add_f32 v38, v38, v39
    s_nop 1
    v_add_f32_dpp v38, v38, v38 row_ror:8 row_mask:0xf bank_mask:0xf
    s_nop 1
    v_add_f32_dpp v38, v38, v38 row_ror:4 row_mask:0xf bank_mask:0xf
    s_nop 1
    v_add_f32_dpp v38, v38, v38 row_ror:2 row_mask:0xf bank_mask:0xf
    s_nop 1
    v_add_f32_dpp v38, v38, v38 row_ror:1 row_mask:0xf bank_mask:0xf
    v_mov_b32 v39, v38
    s_nop 1
    v_permlane16_swap_b32 v38, v39
    v_add_f32 v38, v38, v39
    v_mul_f32 v38, 3135475257, v38
    v_mov_b32 v39, v38
    v_pk_add_f32 v[10:11], v[20:21], v[38:39]
    v_pk_mul_f32 v[12:13], v[10:11], v[10:11]
    v_pk_add_f32 v[10:11], v[22:23], v[38:39]
    v_pk_fma_f32 v[12:13], v[10:11], v[10:11], v[12:13]
    v_pk_add_f32 v[10:11], v[24:25], v[38:39]
    v_pk_fma_f32 v[12:13], v[10:11], v[10:11], v[12:13]
    v_pk_add_f32 v[10:11], v[26:27], v[38:39]
    v_pk_fma_f32 v[12:13], v[10:11], v[10:11], v[12:13]
    v_pk_add_f32 v[10:11], v[28:29], v[38:39]
    v_pk_fma_f32 v[12:13], v[10:11], v[10:11], v[12:13]
    v_pk_add_f32 v[10:11], v[30:31], v[38:39]
    v_pk_fma_f32 v[12:13], v[10:11], v[10:11], v[12:13]
    v_pk_add_f32 v[10:11], v[32:33], v[38:39]
    v_pk_fma_f32 v[12:13], v[10:11], v[10:11], v[12:13]
    v_pk_add_f32 v[10:11], v[34:35], v[38:39]
    v_pk_fma_f32 v[12:13], v[10:11], v[10:11], v[12:13]
    v_pk_add_f32 v[10:11], v[36:37], v[38:39]
    v_pk_fma_f32 v[12:13], v[10:11], v[10:11], v[12:13]
    v_add_f32 v42, v12, v13
    s_nop 1
    v_add_f32_dpp v42, v42, v42 row_ror:8 row_mask:0xf bank_mask:0xf
    s_nop 1
    v_add_f32_dpp v42, v42, v42 row_ror:4 row_mask:0xf bank_mask:0xf
    s_nop 1
    v_add_f32_dpp v42, v42, v42 row_ror:2 row_mask:0xf bank_mask:0xf
    s_nop 1
    v_add_f32_dpp v42, v42, v42 row_ror:1 row_mask:0xf bank_mask:0xf
    v_mov_b32 v41, v42
    s_nop 1
    v_permlane16_swap_b32 v42, v41
    v_add_f32 v42, v42, v41
    v_mul_f32 v42, 987991609, v42
    v_cvt_pk_bf16_f32 v41, v38, v42
    v_lshlrev_b32 v38, 16, v41
    v_and_b32 v42, 0xffff0000, v41
    v_mov_b32 v39, v38
    v_add_f32 v42, 925353388, v42
    v_cvt_pk_bf16_f32 v42, v42, v42
    v_lshlrev_b32 v42, 16, v42
    v_sqrt_f32 v42, v42
    s_nop 0
    v_cvt_pk_bf16_f32 v42, v42, v42
    v_lshlrev_b32 v42, 16, v42
    v_rcp_f32 v10, v42
    s_nop 0
    v_mov_b32 v11, v10
    v_pk_add_f32 v[20:21], v[20:21], v[38:39]
    v_cvt_pk_bf16_f32 v41, v20, v21
    v_lshlrev_b32 v20, 16, v41
    v_and_b32 v21, 0xffff0000, v41
    v_pk_mul_f32 v[20:21], v[20:21], v[10:11]
    v_cvt_pk_bf16_f32 v20, v20, v21
    ds_write_b32 v2, v20 offset:0
    v_pk_add_f32 v[22:23], v[22:23], v[38:39]
    v_cvt_pk_bf16_f32 v41, v22, v23
    v_lshlrev_b32 v22, 16, v41
    v_and_b32 v23, 0xffff0000, v41
    v_pk_mul_f32 v[22:23], v[22:23], v[10:11]
    v_cvt_pk_bf16_f32 v22, v22, v23
    ds_write_b32 v2, v22 offset:4
    v_pk_add_f32 v[24:25], v[24:25], v[38:39]
    v_cvt_pk_bf16_f32 v41, v24, v25
    v_lshlrev_b32 v24, 16, v41
    v_and_b32 v25, 0xffff0000, v41
    v_pk_mul_f32 v[24:25], v[24:25], v[10:11]
    v_cvt_pk_bf16_f32 v24, v24, v25
    ds_write_b32 v2, v24 offset:8
    v_pk_add_f32 v[26:27], v[26:27], v[38:39]
    v_cvt_pk_bf16_f32 v41, v26, v27
    v_lshlrev_b32 v26, 16, v41
    v_and_b32 v27, 0xffff0000, v41
    v_pk_mul_f32 v[26:27], v[26:27], v[10:11]
    v_cvt_pk_bf16_f32 v26, v26, v27
    ds_write_b32 v2, v26 offset:12
    v_pk_add_f32 v[28:29], v[28:29], v[38:39]
    v_cvt_pk_bf16_f32 v41, v28, v29
    v_lshlrev_b32 v28, 16, v41
    v_and_b32 v29, 0xffff0000, v41
    v_pk_mul_f32 v[28:29], v[28:29], v[10:11]
    v_cvt_pk_bf16_f32 v28, v28, v29
    ds_write_b32 v2, v28 offset:16
    v_pk_add_f32 v[30:31], v[30:31], v[38:39]
    v_cvt_pk_bf16_f32 v41, v30, v31
    v_lshlrev_b32 v30, 16, v41
    v_and_b32 v31, 0xffff0000, v41
    v_pk_mul_f32 v[30:31], v[30:31], v[10:11]
    v_cvt_pk_bf16_f32 v30, v30, v31
    ds_write_b32 v2, v30 offset:20
    v_pk_add_f32 v[32:33], v[32:33], v[38:39]
    v_cvt_pk_bf16_f32 v41, v32, v33
    v_lshlrev_b32 v32, 16, v41
    v_and_b32 v33, 0xffff0000, v41
    v_pk_mul_f32 v[32:33], v[32:33], v[10:11]
    v_cvt_pk_bf16_f32 v32, v32, v33
    ds_write_b32 v2, v32 offset:24
    v_pk_add_f32 v[34:35], v[34:35], v[38:39]
    v_cvt_pk_bf16_f32 v41, v34, v35
    v_lshlrev_b32 v34, 16, v41
    v_and_b32 v35, 0xffff0000, v41
    v_pk_mul_f32 v[34:35], v[34:35], v[10:11]
    v_cvt_pk_bf16_f32 v34, v34, v35
    ds_write_b32 v2, v34 offset:28
    v_pk_add_f32 v[36:37], v[36:37], v[38:39]
    v_cvt_pk_bf16_f32 v41, v36, v37
    v_lshlrev_b32 v36, 16, v41
    v_and_b32 v37, 0xffff0000, v41
    v_pk_mul_f32 v[36:37], v[36:37], v[10:11]
    v_cvt_pk_bf16_f32 v36, v36, v37
    ds_write_b32 v2, v36 offset:32
    s_mov_b32 s46, 2097152
L_wqw:
    ds_read_b32 v3, v6 offset:2944
    s_waitcnt lgkmcnt(0)
    v_cmp_eq_u32 vcc, 0, v3
    s_cbranch_vccz L_wqok
    s_sleep 1
    s_sub_u32 s46, s46, 1
    s_cbranch_scc0 L_wqw
L_wqok:
    ds_read_b64 v[20:21], v4 offset:0
    ds_read_b64 v[22:23], v4 offset:32
    ds_read_b64 v[24:25], v4 offset:64
    ds_read_b64 v[26:27], v4 offset:96
    ds_read_b64 v[28:29], v4 offset:128
    ds_read_b64 v[30:31], v4 offset:160
    ds_read_b64 v[32:33], v4 offset:192
    ds_read_b64 v[34:35], v4 offset:224
    ds_read_b64 v[36:37], v4 offset:256
    s_mul_i32 s63, s62, 2654435761
    s_add_u32 s63, s63, 2135587861
    s_add_u32 s62, s62, 1
    s_and_b32 s60, s62, 15
    s_xor_b32 s61, s60, 8
    s_bfe_u32 s35, s30, 0x20010
    s_bfe_u32 s36, s30, 0x50018
    ds_read_b64_tr_b16 v[64:65], v44 offset:0
    ds_read_b64_tr_b16 v[66:67], v44 offset:2048
    ds_read_b64_tr_b16 v[68:69], v44 offset:4096
    ds_read_b64_tr_b16 v[70:71], v44 offset:6144
    ds_read_b64_tr_b16 v[72:73], v44 offset:8192
    ds_read_b64_tr_b16 v[74:75], v44 offset:10240
    ds_read_b64_tr_b16 v[76:77], v44 offset:12288
    ds_read_b64_tr_b16 v[78:79], v44 offset:14336
    ds_read_b64_tr_b16 v[80:81], v44 offset:16384
    ds_read_b64_tr_b16 v[82:83], v45 offset:0
    ds_read_b64_tr_b16 v[84:85], v45 offset:2048
    ds_read_b64_tr_b16 v[86:87], v45 offset:4096
    ds_read_b64_tr_b16 v[88:89], v45 offset:6144
    ds_read_b64_tr_b16 v[90:91], v45 offset:8192
    ds_read_b64_tr_b16 v[92:93], v45 offset:10240
    ds_read_b64_tr_b16 v[94:95], v45 offset:12288
    ds_read_b64_tr_b16 v[96:97], v45 offset:14336
    ds_read_b64_tr_b16 v[98:99], v45 offset:16384
    ds_read_b64_tr_b16 v[100:101], v46 offset:0
    ds_read_b64_tr_b16 v[102:103], v46 offset:2048
    ds_read_b64_tr_b16 v[104:105], v46 offset:4096
    ds_read_b64_tr_b16 v[106:107], v46 offset:6144
    ds_read_b64_tr_b16 v[108:109], v46 offset:8192
    ds_read_b64_tr_b16 v[110:111], v46 offset:10240
    ds_read_b64_tr_b16 v[112:113], v46 offset:12288
    ds_read_b64_tr_b16 v[114:115], v46 offset:14336
    ds_read_b64_tr_b16 v[116:117], v46 offset:16384
    ds_read_b64_tr_b16 v[118:119], v47 offset:0
    ds_read_b64_tr_b16 v[120:121], v47 offset:2048
    ds_read_b64_tr_b16 v[122:123], v47 offset:4096
    ds_read_b64_tr_b16 v[124:125], v47 offset:6144
    ds_read_b64_tr_b16 v[126:127], v47 offset:8192
    ds_read_b64_tr_b16 v[128:129], v47 offset:10240
    ds_read_b64_tr_b16 v[130:131], v47 offset:12288
    ds_read_b64_tr_b16 v[132:133], v47 offset:14336
    ds_read_b64_tr_b16 v[134:135], v47 offset:16384
    s_waitcnt lgkmcnt(0)
    v_mfma_f32_16x16x32_bf16 v[140:143], v[20:23], v[64:67], 0
    v_mfma_f32_16x16x32_bf16 v[144:147], v[20:23], v[82:85], 0
    v_mfma_f32_16x16x32_bf16 v[148:151], v[20:23], v[100:103], 0
    v_mfma_f32_16x16x32_bf16 v[152:155], v[20:23], v[118:121], 0
    v_mfma_f32_16x16x32_bf16 v[140:143], v[24:27], v[68:71], v[140:143]
    v_mfma_f32_16x16x32_bf16 v[144:147], v[24:27], v[86:89], v[144:147]
    v_mfma_f32_16x16x32_bf16 v[148:151], v[24:27], v[104:107], v[148:151]
    v_mfma_f32_16x16x32_bf16 v[152:155], v[24:27], v[122:125], v[152:155]
    v_mfma_f32_16x16x32_bf16 v[140:143], v[28:31], v[72:75], v[140:143]
    v_mfma_f32_16x16x32_bf16 v[144:147], v[28:31], v[90:93], v[144:147]
    v_mfma_f32_16x16x32_bf16 v[148:151], v[28:31], v[108:111], v[148:151]
    v_mfma_f32_16x16x32_bf16 v[152:155], v[28:31], v[126:129], v[152:155]
    v_mfma_f32_16x16x32_bf16 v[140:143], v[32:35], v[76:79], v[140:143]
    v_mfma_f32_16x16x32_bf16 v[144:147], v[32:35], v[94:97], v[144:147]
    v_mfma_f32_16x16x32_bf16 v[148:151], v[32:35], v[112:115], v[148:151]
    v_mfma_f32_16x16x32_bf16 v[152:155], v[32:35], v[130:133], v[152:155]
    v_mfma_f32_16x16x16_bf16 v[140:143], v[36:37], v[80:81], v[140:143]
    v_mfma_f32_16x16x16_bf16 v[144:147], v[36:37], v[98:99], v[144:147]
    v_mfma_f32_16x16x16_bf16 v[148:151], v[36:37], v[116:117], v[148:151]
    v_mfma_f32_16x16x16_bf16 v[152:155], v[36:37], v[134:135], v[152:155]
    v_mov_b32 v23, s63
    v_mov_b32 v22, -16
    s_nop 3
    v_cndmask_b32 v46, v140, v144, s[58:59]
    s_nop 0
    v_cndmask_b32 v47, v148, v152, s[58:59]
    v_add_u32 v46, 8, v46
    v_add_u32 v47, 8, v47
    v_and_or_b32 v46, v46, v22, s60
    v_and_or_b32 v47, v47, v22, s61
    s_or_b32 s50, s50, s51
    v_mov_b32 v22, s50
    s_lshl3_add_u32 s3, s44, 4096
    v_mov_b32 v4, s3
    s_lshl_b32 s3, s44, 6
    s_add_u32 s3, s3, 1966080
    v_mov_b32 v27, s3
    s_waitcnt vmcnt(0)
    global_store_dwordx2 v43, v[46:47], s[28:29]
    s_mov_b64 exec, 1
    global_store_dwordx2 v4, v[22:23], s[28:29]
    s_mov_b64 exec, -1
    v_add_u32 v43, 1048576, v43
    s_lshl_b32 s3, s37, 13
    s_and_b32 s46, s32, 15
    s_lshl4_add_u32 s3, s46, s3
    s_add_u32 s3, s3, 2097152
    v_lshrrev_b32 v8, 1, v0
    v_lshl_add_u32 v8, v8, 8, s3
    v_and_b32 v9, 1, v0
    v_lshl_add_u32 v8, v9, 3, v8
    s_lshl_b32 s3, s36, 8
    s_add_u32 s3, s3, s56
    v_lshl_add_u32 v5, v0, 2, s3
    s_and_b32 s3, s32, 16
    s_lshl1_add_u32 s46, s3, s46
    s_lshl2_add_u32 s46, s46, s56
    s_add_u32 s46, s46, 2304
    v_bfe_u32 v9, v0, 3, 1
    v_lshl_add_u32 v9, v9, 6, s46
    s_bfe_u32 s45, s32, 0x10003
    s_lshl3_add_u32 s44, s37, s45
    s_lshl_b32 s44, s44, 10
    s_add_u32 s44, s44, 2232320
    v_lshl_add_u32 v44, v0, 4, s44
    s_lshl_b32 s3, s31, 8
    s_add_u32 s3, s3, 4096
    v_and_b32 v45, 31, v0
    v_lshl_add_u32 v45, v45, 3, s3
    s_waitcnt vmcnt(0)
    s_mov_b32 s46, 0
L_qpoll:
    global_load_dwordx2 v[80:81], v45, s[28:29] sc1
    global_load_dwordx4 v[64:67], v44, s[28:29] offset:-4096 sc1
    global_load_dwordx4 v[68:71], v44, s[28:29] offset:-2048 sc1
    global_load_dwordx4 v[72:75], v44, s[28:29] offset:0 sc1
    global_load_dwordx4 v[76:79], v44, s[28:29] offset:2048 sc1
    s_waitcnt vmcnt(0)
    v_xor_b32 v64, s60, v64
    v_xor_b32 v65, s61, v65
    v_xor_b32 v66, s60, v66
    v_xor_b32 v67, s61, v67
    v_xor_b32 v68, s60, v68
    v_xor_b32 v69, s61, v69
    v_xor_b32 v70, s60, v70
    v_xor_b32 v71, s61, v71
    v_xor_b32 v72, s60, v72
    v_xor_b32 v73, s61, v73
    v_xor_b32 v74, s60, v74
    v_xor_b32 v75, s61, v75
    v_xor_b32 v76, s60, v76
    v_xor_b32 v77, s61, v77
    v_xor_b32 v78, s60, v78
    v_xor_b32 v79, s61, v79
    v_or_b32 v20, v64, v65
    v_or3_b32 v20, v20, v66, v67
    v_or3_b32 v20, v20, v68, v69
    v_or3_b32 v20, v20, v70, v71
    v_or3_b32 v20, v20, v72, v73
    v_or3_b32 v20, v20, v74, v75
    v_or3_b32 v20, v20, v76, v77
    v_or3_b32 v20, v20, v78, v79
    v_and_b32 v20, 15, v20
    v_cmp_ne_u32 vcc, 0, v20
    s_cbranch_vccz L_qgo
    s_add_u32 s46, s46, 1
    s_cmp_lt_u32 s46, 4
    s_cbranch_scc1 L_qpoll
    s_cmp_lt_u32 s46, 262144
    s_cbranch_scc1 L_qslow
L_qgo:
    v_pk_add_f32 v[64:65], v[64:65], v[68:69]
    v_pk_add_f32 v[66:67], v[66:67], v[70:71]
    v_pk_add_f32 v[72:73], v[72:73], v[76:77]
    v_pk_add_f32 v[74:75], v[74:75], v[78:79]
    v_pk_add_f32 v[64:65], v[64:65], v[72:73]
    v_pk_add_f32 v[66:67], v[66:67], v[74:75]
    v_cvt_pk_bf16_f32 v20, v64, v66
    v_cvt_pk_bf16_f32 v21, v65, v67
    v_and_b32 v4, 0xc0, v40
    v_add3_u32 v4, v4, v40, s57
    ds_write2_b32 v4, v20, v21 offset0:0 offset1:16
    s_lshl_b32 s3, s31, 11
    s_add_u32 s3, s3, 1966080
    v_and_b32 v26, 31, v0
    v_lshl_add_u32 v26, v26, 6, s3
    s_mov_b32 s40, s16
    s_mov_b32 s41, s17
    s_mov_b32 s42, 5308416
    s_mov_b32 s43, 0x20000
    s_mov_b32 s52, s20
    s_mov_b32 s53, s21
    s_mov_b32 s54, 5308416
    s_mov_b32 s55, 0x20000
    s_lshl_b32 s50, s33, 12
    s_add_u32 s50, s50, 45056
    v_lshrrev_b32 v6, 3, v0
    v_and_b32 v3, 2, v6
    v_bfe_u32 v2, v0, 2, 1
    v_lshl_add_u32 v6, v2, 4, v6
    v_mul_u32_u24 v6, 9216, v6
    v_xor_b32 v2, v3, v0
    v_and_b32 v2, 3, v2
    v_lshl_add_u32 v6, v2, 4, v6
    v_lshrrev_b32 v2, 3, v0
    v_and_b32 v7, 6, v2
    v_xor_b32 v7, v7, v0
    v_and_b32 v7, 7, v7
    v_lshlrev_b32 v7, 4, v7
    v_mul_u32_u24 v2, 1152, v2
    v_add_u32 v7, v7, v2
    v_bfe_u32 v2, v0, 2, 1
    v_and_b32 v21, 3, v0
    v_lshl_add_u32 v21, v2, 4, v21
    v_lshrrev_b32 v2, 4, v0
    v_lshl_add_u32 v21, v2, 2, v21
    v_lshlrev_b32 v21, 1, v21
    v_and_b32 v2, 1, v0
    v_lshlrev_b32 v2, 4, v2
    s_mov_b32 s47, 0xffff
    v_lshlrev_b32 v2, v2, s47
    v_bfe_u32 v3, v0, 1, 2
    v_cmp_eq_u32 vcc, 0, v3
    s_nop 1
    v_cndmask_b32 v12, 0, v2, vcc
    v_cmp_eq_u32 vcc, 1, v3
    s_nop 1
    v_cndmask_b32 v13, 0, v2, vcc
    v_cmp_eq_u32 vcc, 2, v3
    s_nop 1
    v_cndmask_b32 v14, 0, v2, vcc
    v_cmp_eq_u32 vcc, 3, v3
    s_nop 1
    v_cndmask_b32 v15, 0, v2, vcc
    s_mov_b32 s46, 0
    s_mov_b32 s34, 0
L_fpoll:
    v_and_b32 v2, 15, v80
    v_cmp_ne_u32 s[44:45], s63, v81
    v_cmp_ne_u32 vcc, s51, v2
    s_andn2_b32 s3, vcc_lo, s44
    s_cbranch_scc1 L_far
    s_cmp_eq_u64 s[44:45], 0
    s_cbranch_scc0 L_fretry2
L_fgo:
    s_cmp_eq_u32 s35, 1
    s_cbranch_scc0 L_nof
    s_lshl3_add_u32 s3, s31, s36
    s_lshl_b32 s3, s3, 11
    s_add_u32 s3, s3, 2097152
    v_lshl_add_u32 v42, v0, 5, s3
    s_cmp_eq_u32 s36, 8
    s_cbranch_scc0 L_pw
    s_add_u32 s3, s56, 2304
    v_add_u32 v42, s3, v40
L_pw:
    global_load_dword v58, v42, s[28:29] sc1
L_nof:
    s_cmp_eq_u32 s32, 2
    s_cbranch_scc0 L_c2
    v_lshrrev_b32 v2, 4, v80
    v_sub_u32 v3, 0, v2
    v_and_b32 v4, 1, v0
    v_cmp_ne_u32 vcc, 0, v4
    s_nop 1
    v_cndmask_b32 v2, v2, v3, vcc
    s_nop 1
    v_add_u32_dpp v2, v2, v2 row_ror:8 row_mask:0xf bank_mask:0xf
    s_nop 1
    v_add_u32_dpp v2, v2, v2 row_ror:4 row_mask:0xf bank_mask:0xf
    s_nop 1
    v_add_u32_dpp v2, v2, v2 row_ror:2 row_mask:0xf bank_mask:0xf
    s_nop 1
    v_add_u32_dpp v2, v2, v2 row_ror:1 row_mask:0xf bank_mask:0xf
    s_nop 0
    v_readlane_b32 s3, v2, 0
    v_readlane_b32 s44, v2, 16
    s_add_u32 s3, s3, s44
    s_cmp_gt_i32 s3, 0
    s_cselect_b32 s3, 4, 0
    s_xor_b32 s3, s3, s51
    s_and_b32 s3, s3, 4
    s_lshl_b32 s3, s3, 6
    s_or_b32 s3, s3, s51
    v_mov_b32 v22, s3
    s_lshl_b32 s3, s31, 7
    s_add_u32 s3, s3, 1024
    v_lshl_add_u32 v4, v0, 3, s3
    s_mov_b64 exec, 0xffff
    global_store_dwordx2 v4, v[22:23], s[28:29] sc1
    s_mov_b64 exec, -1
L_c2:
    v_and_b32 v44, 7, v0
    v_lshlrev_b32 v44, 7, v44
    v_and_b32 v4, 15, v0
    v_lshlrev_b32 v4, 3, v4
    s_mov_b32 s46, 2097152
L_stw:
    ds_read_b64 v[60:61], v4 offset:2816
    s_waitcnt lgkmcnt(0)
    v_cmp_eq_u32 vcc, 0, v61
    s_cbranch_vccz L_stok
    s_sleep 2
    s_sub_u32 s46, s46, 1
    s_cbranch_scc0 L_stw
L_stok:
    s_mov_b32 s38, 1
    s_cmp_eq_u32 s35, 1
    s_cbranch_scc1 L_notick
    s_add_u32 s3, s56, 2560
    s_atomic_add s38, s[28:29], s3 glc
    global_load_dwordx2 v[64:65], v44, s[28:29] offset:1024 sc1
L_notick:
    v_mov_b32 v62, v60
    s_nop 1
    v_max_f32_dpp v62, v62, v62 quad_perm:[1,0,3,2] row_mask:0xf bank_mask:0xf
    s_nop 1
    v_max_f32_dpp v62, v62, v62 quad_perm:[2,3,0,1] row_mask:0xf bank_mask:0xf
    s_nop 1
    v_max_f32_dpp v62, v62, v62 row_half_mirror row_mask:0xf bank_mask:0xf
    v_sub_f32 v60, v60, v62
    v_exp_f32 v60, v60
    s_nop 0
    v_mul_f32 v61, v61, v60
    s_nop 1
    v_add_f32_dpp v61, v61, v61 quad_perm:[1,0,3,2] row_mask:0xf bank_mask:0xf
    s_nop 1
    v_add_f32_dpp v61, v61, v61 quad_perm:[2,3,0,1] row_mask:0xf bank_mask:0xf
    s_nop 1
    v_add_f32_dpp v61, v61, v61 row_half_mirror row_mask:0xf bank_mask:0xf
    v_rcp_f32 v59, v61
    v_log_f32 v61, v61
    v_mul_f32 v60, v60, v59
    v_add_f32 v62, v61, v62
    s_mov_b64 exec, 0x101
    s_cmp_eq_u32 s34, 0
    s_cbranch_scc1 L_stnear
    global_store_dword v9, v62, s[28:29] sc1
    s_branch L_stdone
L_stnear:
    global_store_dword v9, v62, s[28:29]
L_stdone:
    s_mov_b64 exec, -1
    v_lshrrev_b32 v4, 1, v4
    ds_write_b32 v4, v60 offset:3072
    v_lshrrev_b32 v4, 5, v0
    v_lshlrev_b32 v4, 5, v4
    ds_read_b128 v[48:51], v4 offset:3072
    ds_read_b128 v[52:55], v4 offset:3088
    s_waitcnt lgkmcnt(0)
    s_sub_u32 s3, s38, 1
    s_add_u32 s38, s38, 1
    s_cmp_lt_u32 s3, 8
    s_cselect_b32 s47, 2, 3
    s_lshr_b32 s44, s38, 1
    s_lshl_b32 s45, s44, 2
    s_mov_b32 s58, 0x65421003
    s_mov_b32 s59, 7
    s_lshr_b64 s[58:59], s[58:59], s45
    s_and_b32 s45, s58, 7
    s_lshl3_add_u32 s45, s31, s45
    s_add_u32 s3, s31, 64
    s_cmp_eq_u32 s44, 1
    s_cselect_b32 s45, s3, s45
    s_and_b32 s3, s38, 1
    s_lshl1_add_u32 s45, s45, s3
    s_mul_i32 s3, s31, 5
    s_add_u32 s3, s3, s38
    s_add_u32 s3, s3, 126
    s_cmp_lt_u32 s38, 23
    s_cselect_b32 s3, s3, 0xff
    s_cmp_lt_u32 s38, 18
    s_cselect_b32 s38, s45, s3
    s_cmp_eq_u32 s35, 1
    s_cbranch_scc1 L_cgo
    s_cmp_lt_u32 s38, 144
    s_cbranch_scc0 L_notr
    v_and_b32 v4, 28, v40
    s_mov_b32 s46, 2097152
L_lvw:
    ds_read_b32 v3, v4 offset:2976
    s_waitcnt lgkmcnt(0)
    v_cmp_eq_u32 vcc, 0, v3
    s_cbranch_vccz L_lvok
    s_sleep 1
    s_sub_u32 s46, s46, 1
    s_cbranch_scc0 L_lvw
L_lvok:
    s_mul_i32 s45, s38, 36864
    s_mov_b32 m0, 81920
    s_nop 0
    buffer_load_dwordx4 v7, s[52:55], s45 offen nt lds
    s_mov_b32 m0, 86016
    s_add_u32 s45, s45, 128
    buffer_load_dwordx4 v7, s[52:55], s45 offen nt lds
    s_mov_b32 m0, 90112
    s_add_u32 s45, s45, 128
    buffer_load_dwordx4 v7, s[52:55], s45 offen nt lds
    s_mov_b32 m0, 94208
    s_add_u32 s45, s45, 128
    buffer_load_dwordx4 v7, s[52:55], s45 offen nt lds
    s_mov_b32 m0, 98304
    s_add_u32 s45, s45, 128
    buffer_load_dwordx4 v7, s[52:55], s45 offen nt lds
    s_mov_b32 m0, 102400
    s_add_u32 s45, s45, 128
    buffer_load_dwordx4 v7, s[52:55], s45 offen nt lds
    s_mov_b32 m0, 106496
    s_add_u32 s45, s45, 128
    buffer_load_dwordx4 v7, s[52:55], s45 offen nt lds
    s_mov_b32 m0, 110592
    s_add_u32 s45, s45, 128
    buffer_load_dwordx4 v7, s[52:55], s45 offen nt lds
    s_mov_b32 m0, 114688
    s_add_u32 s45, s45, 128
    buffer_load_dwordx4 v7, s[52:55], s45 offen nt lds
    s_mov_b32 m0, 82944
    s_add_u32 s45, s45, 8192
    buffer_load_dwordx4 v7, s[52:55], s45 offen nt lds
    s_mov_b32 m0, 87040
    s_add_u32 s45, s45, 128
    buffer_load_dwordx4 v7, s[52:55], s45 offen nt lds
    s_mov_b32 m0, 91136
    s_add_u32 s45, s45, 128
    buffer_load_dwordx4 v7, s[52:55], s45 offen nt lds
    s_mov_b32 m0, 95232
    s_add_u32 s45, s45, 128
    buffer_load_dwordx4 v7, s[52:55], s45 offen nt lds
    s_mov_b32 m0, 99328
    s_add_u32 s45, s45, 128
    buffer_load_dwordx4 v7, s[52:55], s45 offen nt lds
    s_mov_b32 m0, 103424
    s_add_u32 s45, s45, 128
    buffer_load_dwordx4 v7, s[52:55], s45 offen nt lds
    s_mov_b32 m0, 107520
    s_add_u32 s45, s45, 128
    buffer_load_dwordx4 v7, s[52:55], s45 offen nt lds
    s_mov_b32 m0, 111616
    s_add_u32 s45, s45, 128
    buffer_load_dwordx4 v7, s[52:55], s45 offen nt lds
    s_mov_b32 m0, 115712
    s_add_u32 s45, s45, 128
    buffer_load_dwordx4 v7, s[52:55], s45 offen nt lds
    s_cmp_gt_u32 s47, 2
    s_cbranch_scc0 L_trs
    s_mov_b32 m0, 83968
    s_add_u32 s45, s45, 8192
    buffer_load_dwordx4 v7, s[52:55], s45 offen nt lds
    s_mov_b32 m0, 88064
    s_add_u32 s45, s45, 128
    buffer_load_dwordx4 v7, s[52:55], s45 offen nt lds
    s_mov_b32 m0, 92160
    s_add_u32 s45, s45, 128
    buffer_load_dwordx4 v7, s[52:55], s45 offen nt lds
    s_mov_b32 m0, 96256
    s_add_u32 s45, s45, 128
    buffer_load_dwordx4 v7, s[52:55], s45 offen nt lds
    s_mov_b32 m0, 100352
    s_add_u32 s45, s45, 128
    buffer_load_dwordx4 v7, s[52:55], s45 offen nt lds
    s_mov_b32 m0, 104448
    s_add_u32 s45, s45, 128
    buffer_load_dwordx4 v7, s[52:55], s45 offen nt lds
    s_mov_b32 m0, 108544
    s_add_u32 s45, s45, 128
    buffer_load_dwordx4 v7, s[52:55], s45 offen nt lds
    s_mov_b32 m0, 112640
    s_add_u32 s45, s45, 128
    buffer_load_dwordx4 v7, s[52:55], s45 offen nt lds
    s_mov_b32 m0, 116736
    s_add_u32 s45, s45, 128
    buffer_load_dwordx4 v7, s[52:55], s45 offen nt lds
    s_waitcnt vmcnt(27)
    s_branch L_trw
L_trs:
    s_waitcnt vmcnt(18)
    s_branch L_trw
L_notr:
    s_waitcnt vmcnt(0)
L_trw:
    s_mov_b32 s46, 262144
L_cpoll:
    v_cmp_ne_u32 vcc, s63, v65
    s_cbranch_vccz L_cok
    s_sub_u32 s46, s46, 1
    s_cbranch_scc1 L_cok
    global_load_dwordx2 v[64:65], v44, s[28:29] offset:1024 sc1
    s_waitcnt vmcnt(0)
    s_branch L_cpoll
L_cok:
    v_and_b32 v2, 0x100, v64
    v_cmp_ne_u32 vcc, 0, v2
    s_and_b32 s3, vcc_lo, 0xff
    s_bcnt1_i32_b32 s3, s3
    v_and_b32 v2, 4, v64
    v_cmp_ne_u32 vcc, 0, v2
    s_cmp_gt_u32 s3, 4
    s_cselect_b32 s3, 0xff, 0
    s_xor_b32 s30, s3, vcc_lo
    s_and_b32 s30, s30, 0xff
    s_mul_i32 s48, s33, 589824
    s_lshl_b32 s45, s38, 6
    s_add_u32 s48, s48, s45
    s_add_u32 s18, s18, s45
    s_addc_u32 s19, s19, 0
    s_mul_i32 s49, s38, 36864
    s_lshl_b32 s45, s33, 7
    s_add_u32 s49, s49, s45
    s_bitcmp1_b32 s38, 0
    s_cselect_b32 s44, 294912, 0
    s_cselect_b32 s51, 2048, 0
    s_add_u32 s48, s48, s44
    s_add_u32 s51, s51, s50
    s_lshl_b32 s44, s44, 1
    s_sub_u32 s56, 294912, s44
L_cgo:
    s_pack_ll_b32_b16 s3, s47, s30
    v_mov_b32 v4, 0
    v_mov_b32 v64, s38
    v_mov_b32 v65, s3
    v_mov_b32 v66, s34
    v_mov_b32 v67, s62
    ds_write_b128 v4, v[64:67] offset:3600
    v_lshlrev_b32 v4, 4, v0
    s_waitcnt lgkmcnt(0)
    s_barrier
    ds_read_b128 v[64:67], v4 offset:12288
    ds_read_b128 v[68:71], v4 offset:13312
    ds_read_b128 v[72:75], v4 offset:14336
    ds_read_b128 v[76:79], v4 offset:15360
    ds_read_b128 v[80:83], v4 offset:16384
    ds_read_b128 v[84:87], v4 offset:17408
    ds_read_b128 v[88:91], v4 offset:18432
    ds_read_b128 v[92:95], v4 offset:19456
    s_waitcnt lgkmcnt(7)
    v_pk_mul_f32 v[60:61], v[64:65], v[48:49] op_sel_hi:[1,0]
    v_pk_mul_f32 v[62:63], v[66:67], v[48:49] op_sel_hi:[1,0]
    s_waitcnt lgkmcnt(6)
    v_pk_fma_f32 v[60:61], v[68:69], v[48:49], v[60:61] op_sel:[0,1,0]
    v_pk_fma_f32 v[62:63], v[70:71], v[48:49], v[62:63] op_sel:[0,1,0]
    s_waitcnt lgkmcnt(5)
    v_pk_fma_f32 v[60:61], v[72:73], v[50:51], v[60:61] op_sel_hi:[1,0,1]
    v_pk_fma_f32 v[62:63], v[74:75], v[50:51], v[62:63] op_sel_hi:[1,0,1]
    s_waitcnt lgkmcnt(4)
    v_pk_fma_f32 v[60:61], v[76:77], v[50:51], v[60:61] op_sel:[0,1,0]
    v_pk_fma_f32 v[62:63], v[78:79], v[50:51], v[62:63] op_sel:[0,1,0]
    s_waitcnt lgkmcnt(3)
    v_pk_fma_f32 v[60:61], v[80:81], v[52:53], v[60:61] op_sel_hi:[1,0,1]
    v_pk_fma_f32 v[62:63], v[82:83], v[52:53], v[62:63] op_sel_hi:[1,0,1]
    s_waitcnt lgkmcnt(2)
    v_pk_fma_f32 v[60:61], v[84:85], v[52:53], v[60:61] op_sel:[0,1,0]
    v_pk_fma_f32 v[62:63], v[86:87], v[52:53], v[62:63] op_sel:[0,1,0]
    s_waitcnt lgkmcnt(1)
    v_pk_fma_f32 v[60:61], v[88:89], v[54:55], v[60:61] op_sel_hi:[1,0,1]
    v_pk_fma_f32 v[62:63], v[90:91], v[54:55], v[62:63] op_sel_hi:[1,0,1]
    s_waitcnt lgkmcnt(0)
    v_pk_fma_f32 v[60:61], v[92:93], v[54:55], v[60:61] op_sel:[0,1,0]
    v_pk_fma_f32 v[62:63], v[94:95], v[54:55], v[62:63] op_sel:[0,1,0]
    s_cmp_eq_u32 s34, 0
    v_cvt_pk_bf16_f32 v60, v60, v61
    v_cvt_pk_bf16_f32 v61, v62, v63
    s_cbranch_scc0 L_pubfar
    global_store_dwordx2 v8, v[60:61], s[28:29]
L_pubdone:
    s_cmp_eq_u32 s35, 1
    s_cbranch_scc0 L_dyns
    v_lshlrev_b32 v4, 3, v0
    v_add_u32 v6, 8192, v5
    s_barrier
    ds_read2st64_b64 v[64:67], v4 offset0:40 offset1:41
    ds_read2st64_b64 v[68:71], v4 offset0:42 offset1:43
    ds_read2st64_b64 v[72:75], v4 offset0:44 offset1:45
    ds_read2st64_b64 v[76:79], v4 offset0:46 offset1:47
    s_waitcnt lgkmcnt(3)
    v_pk_add_f32 v[64:65], v[64:65], v[66:67]
    s_waitcnt lgkmcnt(2)
    v_pk_add_f32 v[68:69], v[68:69], v[70:71]
    v_pk_add_f32 v[64:65], v[64:65], v[68:69]
    s_waitcnt lgkmcnt(1)
    v_pk_add_f32 v[72:73], v[72:73], v[74:75]
    v_pk_add_f32 v[64:65], v[64:65], v[72:73]
    s_waitcnt lgkmcnt(0)
    v_pk_add_f32 v[76:77], v[76:77], v[78:79]
    v_pk_add_f32 v[64:65], v[64:65], v[76:77]
    v_cvt_pk_bf16_f32 v64, v64, v65
    global_store_dword v5, v64, s[28:29] sc1
    global_store_dword v6, v64, s[28:29] sc1
    s_endpgm
L_qslow:
    s_cmp_eq_u32 s46, 4
    s_cbranch_scc0 L_qnoann
    global_store_dwordx2 v43, v[46:47], s[28:29] sc1
    s_waitcnt vmcnt(0)
    s_mov_b64 exec, 1
    global_store_dwordx2 v27, v[22:23], s[28:29] sc1
    s_mov_b64 exec, -1
L_qnoann:
    s_lshl_b32 s3, s37, 10
    s_add_u32 s3, s3, 1966080
    v_and_b32 v26, 15, v0
    v_lshl_add_u32 v26, v26, 6, s3
    global_load_dwordx2 v[64:65], v26, s[28:29] sc1
    s_waitcnt vmcnt(0)
    v_cmp_ne_u32 vcc, s63, v65
    s_cbranch_vccnz L_qpoll
    v_or_b32 v44, 1048576, v44
    s_branch L_qpoll
L_fretry2:
    s_add_u32 s46, s46, 1
    s_cmp_lt_u32 s46, 4
    s_cbranch_scc1 L_fagain
    s_cmp_eq_u32 s46, 4
    s_cbranch_scc0 L_fnoann
    global_store_dwordx2 v43, v[46:47], s[28:29] sc1
    s_waitcnt vmcnt(0)
    s_mov_b64 exec, 1
    global_store_dwordx2 v27, v[22:23], s[28:29] sc1
    s_mov_b64 exec, -1
L_fnoann:
    global_load_dwordx2 v[66:67], v26, s[28:29] sc1
    s_waitcnt vmcnt(0)
    v_and_b32 v66, 15, v66
    v_cmp_ne_u32 s[44:45], s63, v67
    v_cmp_ne_u32 vcc, s51, v66
    s_andn2_b32 s3, vcc_lo, s44
    s_cbranch_scc1 L_far
    s_cmp_lt_u32 s46, 262144
    s_cbranch_scc0 L_fgo
L_fagain:
    global_load_dwordx2 v[80:81], v45, s[28:29] sc1
    s_waitcnt vmcnt(0)
    s_branch L_fpoll
L_far:
    global_store_dwordx2 v43, v[46:47], s[28:29] sc1
    s_waitcnt vmcnt(0)
    s_mov_b64 exec, 1
    global_store_dwordx2 v27, v[22:23], s[28:29] sc1
    s_mov_b64 exec, -1
    s_mov_b32 s34, 1048576
    v_add_u32 v19, s34, v19
    v_add_u32 v8, s34, v8
    global_store_dwordx2 v19, v[56:57], s[28:29] sc1
    s_waitcnt vmcnt(0)
    s_mov_b64 exec, 1
    global_store_dwordx2 v27, v[22:23], s[28:29] offset:8 sc1
    s_mov_b64 exec, -1
    s_mov_b32 s46, 262144
L_far2:
    s_sleep 8
    global_load_dwordx2 v[80:81], v26, s[28:29] offset:8 sc1
    s_waitcnt vmcnt(0)
    v_cmp_ne_u32 vcc, s63, v81
    s_cbranch_vccz L_nof
    s_sub_u32 s46, s46, 1
    s_cbranch_scc0 L_far2
    s_branch L_nof
L_pubfar:
    global_store_dwordx2 v8, v[60:61], s[28:29] sc1
    s_branch L_pubdone
L_dyns:
    s_cmp_lt_u32 s38, 144
    s_cbranch_scc1 L_s2b
    s_branch L_s3s
L_dyn:
    v_mov_b32 v4, 0
    ds_read_b128 v[8:11], v4 offset:3600
    s_waitcnt lgkmcnt(0)
    v_readfirstlane_b32 s38, v8
    v_readfirstlane_b32 s47, v9
    v_readfirstlane_b32 s62, v11
    s_lshr_b32 s30, s47, 16
    s_and_b32 s47, s47, 15
    s_cmp_lt_u32 s38, 144
    s_cbranch_scc0 L_s3w
    s_mul_i32 s48, s33, 589824
    s_lshl_b32 s45, s38, 6
    s_add_u32 s48, s48, s45
    s_add_u32 s18, s18, s45
    s_addc_u32 s19, s19, 0
    s_mul_i32 s49, s38, 36864
    s_lshl_b32 s45, s33, 7
    s_add_u32 s49, s49, s45
    s_bitcmp1_b32 s38, 0
    s_cselect_b32 s44, 294912, 0
    s_cselect_b32 s51, 2048, 0
    s_add_u32 s48, s48, s44
    s_add_u32 s51, s51, s50
    s_lshl_b32 s44, s44, 1
    s_sub_u32 s56, 294912, s44
L_s2b:
    s_barrier
    global_load_ushort v21, v21, s[18:19]
    s_add_u32 m0, s51, 0
    s_add_u32 s45, s48, 0
    buffer_load_dwordx4 v6, s[40:43], s45 offen lds
    s_add_u32 m0, s51, 1024
    s_add_u32 s45, s48, 73728
    buffer_load_dwordx4 v6, s[40:43], s45 offen lds
    s_cmp_gt_u32 s47, 2
    s_cbranch_scc1 L_trd
    s_add_u32 m0, s50, 38912
    s_add_u32 s45, s49, 18432
    buffer_load_dwordx4 v7, s[52:55], s45 offen nt lds
L_trd:
    s_add_u32 m0, s50, 39936
    s_add_u32 s45, s49, 27648
    buffer_load_dwordx4 v7, s[52:55], s45 offen nt lds
    s_barrier
    s_xor_b32 s51, s51, 2048
    s_add_u32 s48, s48, s56
    s_add_u32 m0, s51, 0
    s_add_u32 s45, s48, 0
    buffer_load_dwordx4 v6, s[40:43], s45 offen nt lds
    s_add_u32 m0, s51, 1024
    s_add_u32 s45, s48, 73728
    buffer_load_dwordx4 v6, s[40:43], s45 offen nt lds
    v_bfe_u32 v4, v0, 4, 1
    v_and_b32 v5, 15, v0
    v_lshl_add_u32 v5, v5, 1, v4
    s_lshl_b32 s3, s33, 8
    v_and_b32 v6, 24, v5
    v_lshl_add_u32 v7, v6, 3, s3
    v_and_b32 v6, 3, v5
    v_lshl_add_u32 v7, v6, 4, v7
    v_and_b32 v6, 4, v5
    v_lshl_add_u32 v7, v6, 1, v7
    v_lshrrev_b32 v4, 4, v5
    v_mul_u32_u24 v4, 1152, v4
    v_and_b32 v6, 8, v5
    v_lshl_add_u32 v4, v6, 3, v4
    v_and_b32 v6, 7, v5
    v_lshl_add_u32 v4, v6, 2, v4
    s_lshl_b32 s3, s33, 7
    v_add_u32 v4, s3, v4
    ds_read_b32 v50, v4 offset:20480
    ds_read_b32 v51, v4 offset:20512
    v_and_b32 v12, 0x3f803f80, v12
    v_and_b32 v13, 0x3f803f80, v13
    v_and_b32 v14, 0x3f803f80, v14
    v_and_b32 v15, 0x3f803f80, v15
    v_lshrrev_b32 v5, 4, v0
    v_bfe_u32 v4, v0, 3, 1
    v_mul_u32_u24 v20, 80, v4
    s_lshl_b32 s3, s33, 8
    s_add_u32 s3, s3, 3840
    v_lshl_add_u32 v9, v4, 7, s3
    v_lshl_add_u32 v9, v5, 4, v9
    v_and_b32 v4, 3, v0
    v_cmp_eq_u32 vcc, 1, v4
    v_mov_b32 v6, 3200
    s_nop 0
    v_cndmask_b32 v9, v9, v6, vcc
    v_lshl_add_u32 v4, v5, 2, v4
    v_bfe_u32 v6, v0, 2, 2
    v_lshl_add_u32 v4, v6, 4, v4
    s_lshl_b32 s3, s33, 3
    v_mul_u32_u24 v10, 80, v4
    v_add_u32 v10, s3, v10
    v_add_u32 v11, s3, v20
    s_mov_b32 s60, 1
    s_movk_i32 s61, 0x100
    s_lshr_b32 s44, s30, s31
    s_and_b32 s44, s44, 1
    s_lshl_b32 s44, s44, 13
    s_lshl_b32 s3, s33, 8
    s_add_u32 s3, s3, s44
    s_add_u32 s3, s3, 65536
    v_and_b32 v6, 6, v5
    v_add_u32 v4, v6, v5
    v_lshlrev_b32 v4, 12, v4
    v_and_b32 v26, 15, v0
    v_lshl_add_u32 v24, v26, 4, s3
    v_add_u32 v24, v24, v4
    v_add_u32 v25, 0x8000, v24
    v_and_b32 v4, 16, v0
    v_cmp_ne_u32 s[58:59], 0, v4
    v_lshrrev_b32 v4, 2, v0
    v_lshl_add_u32 v4, v4, 6, s50
    v_and_b32 v36, 3, v0
    v_lshl_add_u32 v4, v36, 3, v4
    v_bfe_u32 v36, v0, 4, 1
    v_lshl_add_u32 v36, v36, 5, v4
    v_xor_b32 v37, 32, v36
    s_mov_b32 s46, 262144
    v_mov_b32 v28, 0
    v_mov_b32 v29, 0
    v_mov_b32 v30, 0
    s_sub_u32 s39, s33, 1
    s_cmp_lt_u32 s39, 3
    s_cbranch_scc0 L_s2na
    s_and_b32 s44, s38, 0xc0
    s_add_u32 s44, s44, s38
    s_lshl_b32 s44, s44, 7
    s_add_u32 s44, s44, 131072
    s_mul_i32 s3, s39, 12
    v_add_u32 v4, s3, v5
    v_mul_u32_u24 v6, 13, v4
    v_lshrrev_b32 v6, 6, v6
    v_bfe_u32 v6, s30, v6, 1
    v_lshl_add_u32 v6, v6, 13, s44
    v_mul_u32_u24 v28, 49152, v4
    v_add_u32 v28, v28, v6
    v_lshl_add_u32 v28, v26, 3, v28
    v_add_u32 v4, 4, v4
    v_mul_u32_u24 v6, 13, v4
    v_lshrrev_b32 v6, 6, v6
    v_bfe_u32 v6, s30, v6, 1
    v_lshl_add_u32 v6, v6, 13, s44
    v_mul_u32_u24 v29, 49152, v4
    v_add_u32 v29, v29, v6
    v_lshl_add_u32 v29, v26, 3, v29
    v_add_u32 v4, 4, v4
    v_mul_u32_u24 v6, 13, v4
    v_lshrrev_b32 v6, 6, v6
    v_bfe_u32 v6, s30, v6, 1
    v_lshl_add_u32 v6, v6, 13, s44
    v_mul_u32_u24 v30, 49152, v4
    v_add_u32 v30, v30, v6
    v_lshl_add_u32 v30, v26, 3, v30
    s_mul_i32 s3, s39, 12288
    s_add_u32 s3, s3, 81920
    v_lshrrev_b32 v38, 2, v0
    v_bfe_u32 v39, v0, 3, 2
    v_lshl_add_u32 v38, v38, 7, s3
    v_lshl_add_u32 v38, v39, 5, v38
    v_and_b32 v39, 3, v0
    v_lshl_add_u32 v32, v39, 3, v38
    v_xor_b32 v33, 64, v32
    v_xor_b32 v34, 32, v32
    v_xor_b32 v35, 96, v32
    v_mov_b32 v148, 3222493025
    v_mov_b32 v149, 3184710632
    v_mov_b32 v150, 1065353300
    v_mov_b32 v151, 786163455
    v_mov_b32 v38, 987991609
    v_mov_b32 v39, v38
    v_mov_b32 v152, 0xfffff000
    v_mul_u32_u24 v8, 80, v0
    s_lshr_b32 s63, s62, 11
    s_xor_b32 s63, s63, s62
    s_and_b32 s63, s63, 0x7ff
    s_bitset1_b32 s63, 11
    s_and_b32 s62, s62, 0x7ff
L_s2na:
    s_waitcnt vmcnt(2) lgkmcnt(0)
    v_lshlrev_b32 v21, 16, v21
    v_lshlrev_b32 v48, 16, v50
    v_lshlrev_b32 v49, 16, v51
    v_and_b32 v50, 0xffff0000, v50
    v_and_b32 v51, 0xffff0000, v51
    s_cmp_lt_u32 s39, 3
    s_barrier
    s_cbranch_scc0 L_s2nw2
    ds_read_b64_tr_b16 v[80:81], v32 offset:0
    ds_read_b64_tr_b16 v[82:83], v32 offset:2048
    ds_read_b64_tr_b16 v[84:85], v33 offset:0
    ds_read_b64_tr_b16 v[86:87], v33 offset:2048
    ds_read_b64_tr_b16 v[88:89], v34 offset:0
    ds_read_b64_tr_b16 v[90:91], v34 offset:2048
    ds_read_b64_tr_b16 v[92:93], v35 offset:0
    ds_read_b64_tr_b16 v[94:95], v35 offset:2048
    ds_read_b64_tr_b16 v[96:97], v32 offset:4096
    ds_read_b64_tr_b16 v[98:99], v32 offset:6144
    ds_read_b64_tr_b16 v[100:101], v33 offset:4096
    ds_read_b64_tr_b16 v[102:103], v33 offset:6144
    ds_read_b64_tr_b16 v[104:105], v34 offset:4096
    ds_read_b64_tr_b16 v[106:107], v34 offset:6144
    ds_read_b64_tr_b16 v[108:109], v35 offset:4096
    ds_read_b64_tr_b16 v[110:111], v35 offset:6144
    ds_read_b64_tr_b16 v[112:113], v32 offset:8192
    ds_read_b64_tr_b16 v[114:115], v32 offset:10240
    ds_read_b64_tr_b16 v[116:117], v33 offset:8192
    ds_read_b64_tr_b16 v[118:119], v33 offset:10240
    ds_read_b64_tr_b16 v[120:121], v34 offset:8192
    ds_read_b64_tr_b16 v[122:123], v34 offset:10240
    ds_read_b64_tr_b16 v[124:125], v35 offset:8192
    ds_read_b64_tr_b16 v[126:127], v35 offset:10240
L_s2nw2:
    s_waitcnt vmcnt(1)
    global_load_dwordx4 v[40:43], v24, s[28:29] sc1
    global_load_dwordx4 v[44:47], v25, s[28:29] sc1
    s_waitcnt vmcnt(2)
    ds_read_b64_tr_b16 v[64:65], v36 offset:0
    ds_read_b64_tr_b16 v[66:67], v36 offset:1024
    ds_read_b64_tr_b16 v[68:69], v36 offset:2048
    ds_read_b64_tr_b16 v[70:71], v36 offset:3072
    ds_read_b64_tr_b16 v[72:73], v37 offset:0
    ds_read_b64_tr_b16 v[74:75], v37 offset:1024
    ds_read_b64_tr_b16 v[76:77], v37 offset:2048
    ds_read_b64_tr_b16 v[78:79], v37 offset:3072
L_s2poll:
    s_waitcnt vmcnt(1)
    v_mfma_f32_16x16x32_bf16 v[56:59], v[12:15], v[40:43], v[48:51]
    s_waitcnt vmcnt(0)
    v_mfma_f32_16x16x32_bf16 v[56:59], v[12:15], v[44:47], v[56:59]
    s_nop 7
    v_cmp_u_f32 vcc, v56, v56
    v_cvt_pk_bf16_f32 v56, v56, v57
    v_cvt_pk_bf16_f32 v57, v58, v59
    s_cbranch_vccnz L_s2chk
L_s2go:
    ds_write_b64 v7, v[56:57] offset:3840
    ds_read_b128 v[128:131], v9
    ds_read_b128 v[132:135], v9 offset:64
    s_waitcnt lgkmcnt(0)
    v_mfma_f32_16x16x32_bf16 v[136:139], v[128:131], v[64:67], 0
    v_mfma_f32_16x16x32_bf16 v[136:139], v[132:135], v[68:71], v[136:139]
    v_mfma_f32_16x16x32_bf16 v[140:143], v[128:131], v[72:75], 0
    v_mfma_f32_16x16x32_bf16 v[140:143], v[132:135], v[76:79], v[140:143]
    v_mfma_f32_16x16x32_bf16 v[144:147], v[128:131], v[128:131], 0
    v_mfma_f32_16x16x32_bf16 v[144:147], v[132:135], v[132:135], v[144:147]
    s_cmp_lt_u32 s39, 3
    s_nop 4
    v_cndmask_b32 v136, v136, v140, s[58:59]
    v_cndmask_b32 v137, v137, v141, s[58:59]
    ds_write_b64 v10, v[136:137] offset:6144
    s_mov_b64 exec, s[60:61]
    ds_write_b64 v11, v[144:145] offset:3328
    s_mov_b64 exec, -1
    s_waitcnt lgkmcnt(0)
    s_barrier
    s_cbranch_scc0 L_fin
    ds_read_b128 v[60:63], v20 offset:3328
    ds_read_b128 v[64:67], v20 offset:3344
    ds_read_b128 v[68:71], v20 offset:3360
    ds_read_b128 v[72:75], v20 offset:3376
    ds_read_b64 v[76:77], v20 offset:3392
    ds_read_b128 v[128:131], v8 offset:6144
    ds_read_b128 v[132:135], v8 offset:6160
    ds_read_b128 v[136:139], v8 offset:6176
    ds_read_b128 v[140:143], v8 offset:6192
    ds_read_b64 v[144:145], v8 offset:6208
    s_waitcnt lgkmcnt(9)
    v_pk_add_f32 v[60:61], v[60:61], v[62:63]
    s_waitcnt lgkmcnt(8)
    v_pk_add_f32 v[64:65], v[64:65], v[66:67]
    v_pk_add_f32 v[60:61], v[60:61], v[64:65]
    s_waitcnt lgkmcnt(7)
    v_pk_add_f32 v[68:69], v[68:69], v[70:71]
    s_waitcnt lgkmcnt(6)
    v_pk_add_f32 v[72:73], v[72:73], v[74:75]
    s_waitcnt lgkmcnt(5)
    v_pk_add_f32 v[68:69], v[68:69], v[72:73]
    v_pk_add_f32 v[60:61], v[60:61], v[76:77]
    v_pk_add_f32 v[60:61], v[60:61], v[68:69]
    v_pk_mul_f32 v[60:61], v[60:61], v[38:39]
    v_fma_f32 v60, -v61, v61, v60
    v_max_f32 v60, 0, v60
    v_fma_f32 v62, v60, v150, v151
    v_rsq_f32 v62, v62
    s_waitcnt lgkmcnt(0)
    v_pk_add_f32 v[128:129], v[128:129], v[130:131]
    v_pk_add_f32 v[132:133], v[132:133], v[134:135]
    v_pk_add_f32 v[136:137], v[136:137], v[138:139]
    v_pk_add_f32 v[140:141], v[140:141], v[142:143]
    v_pk_add_f32 v[128:129], v[128:129], v[132:133]
    v_pk_add_f32 v[136:137], v[136:137], v[140:141]
    v_pk_add_f32 v[128:129], v[128:129], v[144:145]
    v_pk_add_f32 v[128:129], v[128:129], v[136:137]
    v_fma_f32 v128, -v61, v129, v128
    v_fma_f32 v128, v62, v128, v21
    v_mul_f32 v129, v128, v128
    v_fma_f32 v129, v129, v149, v148
    v_mul_f32 v129, v128, v129
    v_exp_f32 v129, v129
    s_nop 0
    v_add_f32 v129, 1.0, v129
    v_rcp_f32 v129, v129
    s_nop 0
    v_mul_f32 v128, v128, v129
    s_nop 1
    v_mov_b32_dpp v129, v128 row_shl:1 row_mask:0xf bank_mask:0xf
    v_cvt_pk_bf16_f32 v128, v128, v129
    s_nop 1
    v_mov_b32_dpp v129, v128 row_shl:2 row_mask:0xf bank_mask:0xf
    v_mov_b32_dpp v130, v128 row_shl:4 row_mask:0xf bank_mask:0xf
    v_mov_b32_dpp v131, v128 row_shl:6 row_mask:0xf bank_mask:0xf
    s_nop 1
    v_mfma_f32_16x16x32_bf16 v[80:83], v[128:131], v[80:83], 0
    v_mfma_f32_16x16x32_bf16 v[84:87], v[128:131], v[84:87], 0
    v_mfma_f32_16x16x32_bf16 v[88:91], v[128:131], v[88:91], 0
    v_mfma_f32_16x16x32_bf16 v[92:95], v[128:131], v[92:95], 0
    s_nop 1
    v_mfma_f32_16x16x32_bf16 v[96:99], v[128:131], v[96:99], 0
    s_nop 1
    v_mfma_f32_16x16x32_bf16 v[100:103], v[128:131], v[100:103], 0
    v_permlane16_swap_b32 v80, v84
    v_mfma_f32_16x16x32_bf16 v[104:107], v[128:131], v[104:107], 0
    s_nop 0
    v_mfma_f32_16x16x32_bf16 v[108:111], v[128:131], v[108:111], 0
    v_permlane16_swap_b32 v88, v92
    v_mfma_f32_16x16x32_bf16 v[112:115], v[128:131], v[112:115], 0
    v_and_or_b32 v80, v80, v152, s62
    v_and_or_b32 v81, v88, v152, s63
    v_mfma_f32_16x16x32_bf16 v[116:119], v[128:131], v[116:119], 0
    global_store_dwordx2 v28, v[80:81], s[28:29] sc1
    v_mfma_f32_16x16x32_bf16 v[120:123], v[128:131], v[120:123], 0
    v_permlane16_swap_b32 v96, v100
    v_mfma_f32_16x16x32_bf16 v[124:127], v[128:131], v[124:127], 0
    v_permlane16_swap_b32 v104, v108
    v_and_or_b32 v96, v96, v152, s62
    v_and_or_b32 v97, v104, v152, s63
    global_store_dwordx2 v29, v[96:97], s[28:29] sc1
    v_permlane16_swap_b32 v112, v116
    s_nop 2
    v_permlane16_swap_b32 v120, v124
    v_and_or_b32 v112, v112, v152, s62
    v_and_or_b32 v113, v120, v152, s63
    global_store_dwordx2 v30, v[112:113], s[28:29] sc1
    s_endpgm
L_s2chk:
    v_max3_u32 v31, v40, v41, v42
    v_max_u32 v31, v31, v43
    v_cmp_eq_u32 s[94:95], -1, v31
    v_max3_u32 v31, v44, v45, v46
    v_max_u32 v31, v31, v47
    v_cmp_eq_u32 s[96:97], -1, v31
    s_or_b64 s[44:45], s[94:95], s[96:97]
    s_cbranch_scc0 L_s2go
    s_sub_u32 s46, s46, 1
    s_cbranch_scc1 L_s2go
    s_mov_b64 exec, s[94:95]
    s_cbranch_execz L_s2r0
    global_load_dwordx4 v[40:43], v24, s[28:29] sc1
L_s2r0:
    s_mov_b64 exec, s[96:97]
    s_cbranch_execz L_s2r1
    global_load_dwordx4 v[44:47], v25, s[28:29] sc1
L_s2r1:
    s_mov_b64 exec, -1
    s_waitcnt vmcnt(0)
    s_branch L_s2poll
L_s3s:
    s_sub_u32 s38, s38, 144
    s_cmp_ge_u32 s38, 36
    s_cbranch_scc1 L_fin
    s_lshr_b32 s3, s38, 2
    s_lshl_b32 s3, s3, 6
    s_and_b32 s44, s38, 1
    s_lshl_b32 s44, s44, 5
    s_add_u32 s3, s3, s44
    v_and_b32 v4, 7, v0
    v_lshl_add_u32 v6, v4, 1, s3
    v_and_b32 v5, 16, v0
    v_add_u32 v6, v5, v6
    v_lshrrev_b32 v5, 5, v0
    v_add_u32 v6, v6, v5
    v_lshlrev_b32 v6, 1, v6
    s_bfe_u32 s3, s38, 0x10001
    s_mul_i32 s3, s3, 1152
    v_add_u32 v7, s3, v6
    global_load_ushort v20, v7, s[4:5]
    global_load_ushort v21, v6, s[22:23]
    s_lshr_b32 s45, s30, s31
    s_and_b32 s45, s45, 1
    s_lshl_b32 s45, s45, 13
    s_lshl_b32 s3, s38, 6
    s_add_u32 s3, s3, s45
    s_add_u32 s3, s3, 65536
    v_lshrrev_b32 v5, 3, v0
    v_and_b32 v8, 6, v5
    v_add_u32 v5, v8, v5
    v_lshlrev_b32 v5, 12, v5
    v_lshl_add_u32 v5, v4, 3, v5
    v_add_u32 v5, s3, v5
    s_mov_b32 s46, 262144
L_s3hpoll:
    global_load_dwordx2 v[28:29], v5, s[28:29] sc1
    s_waitcnt vmcnt(0)
    v_max_u32 v8, v28, v29
    v_cmp_eq_u32 vcc, -1, v8
    s_cbranch_vccz L_s3hgo
    s_sleep 4
    s_sub_u32 s46, s46, 1
    s_cbranch_scc0 L_s3hpoll
L_s3hgo:
    v_lshlrev_b32 v24, 16, v28
    v_and_b32 v25, 0xffff0000, v28
    v_lshlrev_b32 v26, 16, v29
    v_and_b32 v27, 0xffff0000, v29
    s_nop 0
    v_permlane32_swap_b32 v24, v26
    v_permlane32_swap_b32 v25, v27
    v_pk_add_f32 v[24:25], v[24:25], v[26:27]
    s_nop 1
    v_permlane16_swap_b32 v24, v25
    v_add_f32 v24, v24, v25
    s_nop 1
    v_add_f32_dpp v24, v24, v24 row_ror:8 row_mask:0xf bank_mask:0xf
    v_lshlrev_b32 v20, 16, v20
    v_lshlrev_b32 v21, 16, v21
    v_add_f32 v20, v20, v24
    v_cvt_pk_bf16_f32 v20, v20, v20
    v_lshlrev_b32 v20, 16, v20
    v_add_f32 v20, v20, v21
    s_cmp_eq_u32 s38, 0
    s_cbranch_scc0 L_s3c
    v_mov_b32 v41, s62
    v_mov_b32 v42, 0
    s_mov_b64 exec, 1
    global_store_dword v42, v41, s[28:29] sc1
    s_mov_b64 exec, -1
    s_branch L_s3c
L_s3w:
    s_sub_u32 s38, s38, 144
    s_cmp_ge_u32 s38, 36
    s_cbranch_scc1 L_fin
    v_mov_b32 v7, 0
L_s3c:
    s_lshr_b32 s63, s62, 11
    s_xor_b32 s63, s63, s62
    s_and_b32 s63, s63, 0x7ff
    s_bitset1_b32 s63, 11
    s_and_b32 s62, s62, 0x7ff
    s_lshr_b32 s45, s30, s31
    s_and_b32 s45, s45, 1
    s_lshl_b32 s45, s45, 13
    s_mul_i32 s3, s38, 49152
    s_and_b32 s44, s33, 12
    s_add_u32 s44, s44, s33
    s_lshl_b32 s44, s44, 11
    s_add_u32 s3, s3, s44
    s_add_u32 s3, s3, s45
    s_add_u32 s3, s3, 131072
    v_lshl_add_u32 v1, v0, 4, s3
    v_mov_b32 v10, 0xfff
    v_lshlrev_b32 v2, 2, v0
    s_lshl_b32 s3, s33, 8
    v_add_u32 v3, s3, v2
    s_mov_b32 s46, 262144
    s_barrier
L_h4p:
    global_load_dwordx4 v[48:51], v1, s[28:29] sc1
    global_load_dwordx4 v[52:55], v1, s[28:29] offset:1024 sc1
    s_waitcnt vmcnt(0)
    v_xor_b32 v32, s62, v48
    v_xor_b32 v33, s63, v49
    v_xor_b32 v34, s62, v50
    v_xor_b32 v35, s63, v51
    v_xor_b32 v36, s62, v52
    v_xor_b32 v37, s63, v53
    v_xor_b32 v38, s62, v54
    v_xor_b32 v39, s63, v55
    v_or3_b32 v8, v32, v33, v34
    v_or3_b32 v9, v35, v36, v37
    v_or3_b32 v8, v38, v39, v8
    v_or_b32 v8, v8, v9
    v_and_b32 v8, v8, v10
    v_cmp_ne_u32 vcc, 0, v8
    s_cbranch_vccnz L_h4r
L_h4t:
    s_mov_b64 exec, -1
    v_pk_add_f32 v[32:33], v[32:33], v[36:37]
    v_pk_add_f32 v[34:35], v[34:35], v[38:39]
    s_nop 1
    v_permlane32_swap_b32 v32, v34
    v_permlane32_swap_b32 v33, v35
    v_pk_add_f32 v[32:33], v[32:33], v[34:35]
    s_nop 1
    v_permlane16_swap_b32 v32, v33
    v_add_f32 v32, v32, v33
    s_nop 1
    v_add_f32_dpp v32, v32, v32 row_ror:8 row_mask:0xf bank_mask:0xf
    ds_write_b32 v3, v32 offset:6144
    s_cmp_eq_u32 s33, 0
    s_waitcnt lgkmcnt(0)
    s_barrier
    s_cbranch_scc0 L_fin
    ds_read2st64_b32 v[40:41], v2 offset0:24 offset1:25
    ds_read2st64_b32 v[42:43], v2 offset0:26 offset1:27
    ds_read2st64_b32 v[44:45], v2 offset0:28 offset1:29
    ds_read2st64_b32 v[46:47], v2 offset0:30 offset1:31
    ds_read_b32 v30, v2 offset:8192
    s_mov_b32 exec_lo, 0x00ff00ff
    s_mov_b32 exec_hi, 0x00ff00ff
    s_waitcnt lgkmcnt(0)
    v_pk_add_f32 v[40:41], v[40:41], v[42:43]
    v_pk_add_f32 v[44:45], v[44:45], v[46:47]
    v_add_f32 v30, v30, v20
    v_pk_add_f32 v[40:41], v[40:41], v[44:45]
    v_add_f32 v40, v40, v41
    v_add_f32 v40, v40, v30
    v_cvt_pk_bf16_f32 v40, v40, v40
    global_store_short v7, v40, s[24:25]
L_fin:
L_exit2:
    s_endpgm
L_h4r:
    s_mov_b64 exec, vcc
    s_sub_u32 s46, s46, 1
    s_cbranch_scc0 L_h4p
    s_branch L_h4t
.p2align 7
.type L_table,@object
L_table:
.long 0x10d00
.long 0x1010d00
.long 0x1100
.long 0x1100
.long 0x1100
.long 0x1100
.long 0x1100
.long 0x1100
.long 0x2010d00
.long 0x3010d00
.long 0x1100
.long 0x1100
.long 0x1100
.long 0x1100
.long 0x1100
.long 0x1100
.long 0x4010d00
.long 0x5010d00
.long 0x1100
.long 0x1100
.long 0x1100
.long 0x1100
.long 0x1100
.long 0x1100
.long 0x6010e00
.long 0x7010e00
.long 0x8010e00
.long 0x1200
.long 0x1100
.long 0x1100
.long 0x1100
.long 0x1100
.p2align 8
L_codeend:
.section .rodata,"a"
.p2align 6
.amdhsa_kernel sequential_preLN__sliding_block_cached__mixer_channel_mlp__decode_kernel
  .amdhsa_next_free_vgpr 168
  .amdhsa_next_free_sgpr 102
  .amdhsa_accum_offset 168
  .amdhsa_group_segment_fixed_size 0
  .amdhsa_kernarg_size 104
  .amdhsa_user_sgpr_count 2
  .amdhsa_user_sgpr_kernarg_segment_ptr 1
  .amdhsa_system_sgpr_workgroup_id_x 1
  .amdhsa_float_denorm_mode_32 3
.end_amdhsa_kernel
```
